```python
import torch

def _softmax(x, axis=-1):
    return torch.softmax(x, dim=axis)
def _gelu(x):
    return torch.nn.functional.gelu(x, approximate="tanh")
def _silu(x):
    return torch.nn.functional.silu(x)
def _sigmoid(x):
    return torch.sigmoid(x)
def _layernorm(x, axis=-1, eps=1e-5):
    m = x.mean(dim=axis, keepdim=True)
    v = x.var(dim=axis, keepdim=True, unbiased=False)
    return (x - m) / torch.sqrt(v + eps)
def _scatter_add(tgt, idx, src, axis=0):
    return tgt.clone().index_add_(axis, idx, src)
def _segment_sum(src, seg, n):
    out = torch.zeros((n,) + src.shape[1:], dtype=src.dtype)
    return out.index_add_(0, seg, src)
def _pad(x, pw):
    flat = tuple(v for pair in reversed(pw) for v in pair)
    return torch.nn.functional.pad(x, flat)

kernel_name = 'sequential_preLN__linear_attn_block__glu_gated_geglu__prompt'

def setup_inputs():

    _w = (lambda a: (lambda t: t.to(torch.bfloat16) if t.is_floating_point() else t)(torch.as_tensor(a)))
    def _A_setup():
        B, S, D = 1, 2048, 1024
        return {
            "x": _w((lambda *s: torch.randn(*s, dtype=torch.bfloat16) * 0.05)(B, S, D)),
            "wqkv": _w((lambda *s: torch.randn(*s, dtype=torch.bfloat16) * 0.05)(D, 3 * D)),
            "wo": _w((lambda *s: torch.randn(*s, dtype=torch.bfloat16) * 0.05)(D, D)),
        }
    _A_in = _A_setup()

    def _B_setup():
        B, S, Dm, Df = 1, 2048, 1024, 3584
        return {
            "x": _w((lambda *s: torch.randn(*s, dtype=torch.bfloat16) * 0.05)(B, S, Dm)),
            "w_gate": _w((lambda *s: torch.randn(*s, dtype=torch.bfloat16) * 0.4)(Dm, Df) * (Dm ** -0.5)),
            "w_up": _w((lambda *s: torch.randn(*s, dtype=torch.bfloat16) * 0.4)(Dm, Df) * (Dm ** -0.5)),
            "w_down": _w((lambda *s: torch.randn(*s, dtype=torch.bfloat16) * 0.4)(Df, Dm) * (Df ** -0.5)),
        }
    _B_in = _B_setup()

    return {
        "A_x": _A_in["x"],
        "A_wqkv": _A_in["wqkv"],
        "A_wo": _A_in["wo"],
        "B_x": _B_in["x"],
        "B_w_gate": _B_in["w_gate"],
        "B_w_up": _B_in["w_up"],
        "B_w_down": _B_in["w_down"],
    }

def reference(A_x, A_wqkv, A_wo, B_x, B_w_gate, B_w_up, B_w_down):
    def _A_ref(x, wqkv, wo):
        B, S, D = x.shape
        H = 32; Dh = D // H
        qkv = (lambda x, *d: x.permute(*d))((x @ wqkv).reshape(B, S, 3, H, Dh), 2, 0, 3, 1, 4)
        q, k, v = qkv[0], qkv[1], qkv[2]
        phi = lambda t: torch.where(t > 0, t + 1, torch.exp(t)) + 1e-6
        pq, pk = phi(q), phi(k)
        kv = torch.einsum("bhsd,bhse->bhde", pk, v)
        z = torch.einsum("bhsd->bhd", pk)
        num = torch.einsum("bhqd,bhde->bhqe", pq, kv)
        den = torch.einsum("bhqd,bhd->bhq", pq, z)[..., None] + 1e-6
        o = num / den
        return (lambda x, *d: x.permute(*d))(o, 0, 2, 1, 3).reshape(B, S, D) @ wo

    def _B_ref(x, w_gate, w_up, w_down):
        g = torch.einsum("bsd,df->bsf", x, w_gate)
        u = torch.einsum("bsd,df->bsf", x, w_up)
        h = _gelu(g) * u
        return torch.einsum("bsf,fd->bsd", h, w_down)

    x = A_x
    h = x + _A_ref(_layernorm(x, axis=-1), A_wqkv, A_wo)
    h2 = h + _B_ref(_layernorm(h, axis=-1), B_w_gate, B_w_up, B_w_down)
    return h2
```

```asm
; @launch kernel=k0_ln_kernel grid=(480,1,1) block=(256,1,1) lds=16384
; @launch kernel=k1_qkv_kernel grid=(256,1,1) block=(512,1,1) lds=163840
; @launch kernel=k15_o_kernel grid=(256,1,1) block=(256,1,1) lds=8192
; @launch kernel=k2_wo_kernel grid=(256,1,1) block=(512,1,1) lds=147456
; @launch kernel=k3_glu_kernel grid=(256,1,1) block=(512,1,1) lds=157952
; @launch kernel=k4_down_kernel grid=(256,1,1) block=(512,1,1) lds=147456
.amdgcn_target "amdgcn-amd-amdhsa--gfx950"
.text
.globl k0_ln_kernel
.p2align 8
.type k0_ln_kernel,@function
k0_ln_kernel:
    s_cmp_ge_u32 s2, 480
    s_cbranch_scc1 L_k0_ln_kernel_end_1
    s_load_dwordx4 s[4:7], s[0:1], 0
    s_load_dwordx2 s[20:21], s[0:1], 72
    s_load_dwordx4 s[60:63], s[0:1], 32
    s_load_dwordx2 s[64:65], s[0:1], 16
    s_load_dwordx2 s[66:67], s[0:1], 48
    s_waitcnt lgkmcnt(0)
    s_cmp_lt_u32 s2, 256
    s_cbranch_scc1 L_k0_ln_kernel_ln_2
    s_sub_u32 s3, s2, 256
    s_mov_b32 s6, s20
    s_mov_b32 s7, s21
    s_cmp_ge_u32 s3, 112
    s_cselect_b32 s28, s62, s60
    s_cselect_b32 s29, s63, s61
    s_cselect_b32 s30, 112, 0
    s_cselect_b32 s38, 14336, 0
    s_sub_u32 s31, s3, s30
    s_mul_i32 s32, s31, 2341
    s_lshr_b32 s32, s32, 16
    s_mul_i32 s33, s32, 28
    s_sub_u32 s33, s31, s33
    s_mov_b32 s8, s28
    s_and_b32 s9, s29, 0xffff
    s_mov_b32 s10, 0x700000
    s_mov_b32 s11, 0x00020000
    s_add_u32 s12, s6, 0xb00000
    s_addc_u32 s13, s7, 0
    s_and_b32 s13, s13, 0xffff
    s_mov_b32 s14, 0x1c000
    s_mov_b32 s15, 0x00020000
    v_and_b32 v1, 15, v0
    v_lshrrev_b32 v2, 4, v0
    s_lshl_b32 s34, s33, 8
    s_mul_i32 s35, s32, 1835008
    s_add_u32 s34, s34, s35
    s_movk_i32 s35, 7168
    v_mul_lo_u32 v3, v2, s35
    v_lshl_add_u32 v3, v1, 4, v3
    v_add_u32 v3, s34, v3
    s_mov_b32 s34, 0
    buffer_load_dwordx4 v[16:19], v3, s[8:11], s34 offen
    s_add_u32 s34, s34, 114688
    buffer_load_dwordx4 v[20:23], v3, s[8:11], s34 offen
    s_add_u32 s34, s34, 114688
    buffer_load_dwordx4 v[24:27], v3, s[8:11], s34 offen
    s_add_u32 s34, s34, 114688
    buffer_load_dwordx4 v[28:31], v3, s[8:11], s34 offen
    s_add_u32 s34, s34, 114688
    buffer_load_dwordx4 v[32:35], v3, s[8:11], s34 offen
    s_add_u32 s34, s34, 114688
    buffer_load_dwordx4 v[36:39], v3, s[8:11], s34 offen
    s_add_u32 s34, s34, 114688
    buffer_load_dwordx4 v[40:43], v3, s[8:11], s34 offen
    s_add_u32 s34, s34, 114688
    buffer_load_dwordx4 v[44:47], v3, s[8:11], s34 offen
    s_add_u32 s34, s34, 114688
    buffer_load_dwordx4 v[48:51], v3, s[8:11], s34 offen
    s_add_u32 s34, s34, 114688
    buffer_load_dwordx4 v[52:55], v3, s[8:11], s34 offen
    s_add_u32 s34, s34, 114688
    buffer_load_dwordx4 v[56:59], v3, s[8:11], s34 offen
    s_add_u32 s34, s34, 114688
    buffer_load_dwordx4 v[60:63], v3, s[8:11], s34 offen
    s_add_u32 s34, s34, 114688
    buffer_load_dwordx4 v[64:67], v3, s[8:11], s34 offen
    s_add_u32 s34, s34, 114688
    buffer_load_dwordx4 v[68:71], v3, s[8:11], s34 offen
    s_add_u32 s34, s34, 114688
    buffer_load_dwordx4 v[72:75], v3, s[8:11], s34 offen
    s_add_u32 s34, s34, 114688
    buffer_load_dwordx4 v[76:79], v3, s[8:11], s34 offen
    v_mov_b32 v4, 0xffff0000
    v_mov_b32 v8, 0
    v_mov_b32 v9, 0
    v_mov_b32 v10, 0
    v_mov_b32 v11, 0
    v_mov_b32 v12, 0
    v_mov_b32 v13, 0
    v_mov_b32 v14, 0
    v_mov_b32 v15, 0
    s_waitcnt vmcnt(15)
    v_lshlrev_b32 v5, 16, v16
    v_and_b32 v6, v4, v16
    v_add_f32 v8, v8, v5
    v_add_f32 v9, v9, v6
    v_lshlrev_b32 v5, 16, v17
    v_and_b32 v6, v4, v17
    v_add_f32 v10, v10, v5
    v_add_f32 v11, v11, v6
    v_lshlrev_b32 v5, 16, v18
    v_and_b32 v6, v4, v18
    v_add_f32 v12, v12, v5
    v_add_f32 v13, v13, v6
    v_lshlrev_b32 v5, 16, v19
    v_and_b32 v6, v4, v19
    v_add_f32 v14, v14, v5
    v_add_f32 v15, v15, v6
    s_waitcnt vmcnt(14)
    v_lshlrev_b32 v5, 16, v20
    v_and_b32 v6, v4, v20
    v_add_f32 v8, v8, v5
    v_add_f32 v9, v9, v6
    v_lshlrev_b32 v5, 16, v21
    v_and_b32 v6, v4, v21
    v_add_f32 v10, v10, v5
    v_add_f32 v11, v11, v6
    v_lshlrev_b32 v5, 16, v22
    v_and_b32 v6, v4, v22
    v_add_f32 v12, v12, v5
    v_add_f32 v13, v13, v6
    v_lshlrev_b32 v5, 16, v23
    v_and_b32 v6, v4, v23
    v_add_f32 v14, v14, v5
    v_add_f32 v15, v15, v6
    s_waitcnt vmcnt(13)
    v_lshlrev_b32 v5, 16, v24
    v_and_b32 v6, v4, v24
    v_add_f32 v8, v8, v5
    v_add_f32 v9, v9, v6
    v_lshlrev_b32 v5, 16, v25
    v_and_b32 v6, v4, v25
    v_add_f32 v10, v10, v5
    v_add_f32 v11, v11, v6
    v_lshlrev_b32 v5, 16, v26
    v_and_b32 v6, v4, v26
    v_add_f32 v12, v12, v5
    v_add_f32 v13, v13, v6
    v_lshlrev_b32 v5, 16, v27
    v_and_b32 v6, v4, v27
    v_add_f32 v14, v14, v5
    v_add_f32 v15, v15, v6
    s_waitcnt vmcnt(12)
    v_lshlrev_b32 v5, 16, v28
    v_and_b32 v6, v4, v28
    v_add_f32 v8, v8, v5
    v_add_f32 v9, v9, v6
    v_lshlrev_b32 v5, 16, v29
    v_and_b32 v6, v4, v29
    v_add_f32 v10, v10, v5
    v_add_f32 v11, v11, v6
    v_lshlrev_b32 v5, 16, v30
    v_and_b32 v6, v4, v30
    v_add_f32 v12, v12, v5
    v_add_f32 v13, v13, v6
    v_lshlrev_b32 v5, 16, v31
    v_and_b32 v6, v4, v31
    v_add_f32 v14, v14, v5
    v_add_f32 v15, v15, v6
    s_waitcnt vmcnt(11)
    v_lshlrev_b32 v5, 16, v32
    v_and_b32 v6, v4, v32
    v_add_f32 v8, v8, v5
    v_add_f32 v9, v9, v6
    v_lshlrev_b32 v5, 16, v33
    v_and_b32 v6, v4, v33
    v_add_f32 v10, v10, v5
    v_add_f32 v11, v11, v6
    v_lshlrev_b32 v5, 16, v34
    v_and_b32 v6, v4, v34
    v_add_f32 v12, v12, v5
    v_add_f32 v13, v13, v6
    v_lshlrev_b32 v5, 16, v35
    v_and_b32 v6, v4, v35
    v_add_f32 v14, v14, v5
    v_add_f32 v15, v15, v6
    s_waitcnt vmcnt(10)
    v_lshlrev_b32 v5, 16, v36
    v_and_b32 v6, v4, v36
    v_add_f32 v8, v8, v5
    v_add_f32 v9, v9, v6
    v_lshlrev_b32 v5, 16, v37
    v_and_b32 v6, v4, v37
    v_add_f32 v10, v10, v5
    v_add_f32 v11, v11, v6
    v_lshlrev_b32 v5, 16, v38
    v_and_b32 v6, v4, v38
    v_add_f32 v12, v12, v5
    v_add_f32 v13, v13, v6
    v_lshlrev_b32 v5, 16, v39
    v_and_b32 v6, v4, v39
    v_add_f32 v14, v14, v5
    v_add_f32 v15, v15, v6
    s_waitcnt vmcnt(9)
    v_lshlrev_b32 v5, 16, v40
    v_and_b32 v6, v4, v40
    v_add_f32 v8, v8, v5
    v_add_f32 v9, v9, v6
    v_lshlrev_b32 v5, 16, v41
    v_and_b32 v6, v4, v41
    v_add_f32 v10, v10, v5
    v_add_f32 v11, v11, v6
    v_lshlrev_b32 v5, 16, v42
    v_and_b32 v6, v4, v42
    v_add_f32 v12, v12, v5
    v_add_f32 v13, v13, v6
    v_lshlrev_b32 v5, 16, v43
    v_and_b32 v6, v4, v43
    v_add_f32 v14, v14, v5
    v_add_f32 v15, v15, v6
    s_waitcnt vmcnt(8)
    v_lshlrev_b32 v5, 16, v44
    v_and_b32 v6, v4, v44
    v_add_f32 v8, v8, v5
    v_add_f32 v9, v9, v6
    v_lshlrev_b32 v5, 16, v45
    v_and_b32 v6, v4, v45
    v_add_f32 v10, v10, v5
    v_add_f32 v11, v11, v6
    v_lshlrev_b32 v5, 16, v46
    v_and_b32 v6, v4, v46
    v_add_f32 v12, v12, v5
    v_add_f32 v13, v13, v6
    v_lshlrev_b32 v5, 16, v47
    v_and_b32 v6, v4, v47
    v_add_f32 v14, v14, v5
    v_add_f32 v15, v15, v6
    s_waitcnt vmcnt(7)
    v_lshlrev_b32 v5, 16, v48
    v_and_b32 v6, v4, v48
    v_add_f32 v8, v8, v5
    v_add_f32 v9, v9, v6
    v_lshlrev_b32 v5, 16, v49
    v_and_b32 v6, v4, v49
    v_add_f32 v10, v10, v5
    v_add_f32 v11, v11, v6
    v_lshlrev_b32 v5, 16, v50
    v_and_b32 v6, v4, v50
    v_add_f32 v12, v12, v5
    v_add_f32 v13, v13, v6
    v_lshlrev_b32 v5, 16, v51
    v_and_b32 v6, v4, v51
    v_add_f32 v14, v14, v5
    v_add_f32 v15, v15, v6
    s_waitcnt vmcnt(6)
    v_lshlrev_b32 v5, 16, v52
    v_and_b32 v6, v4, v52
    v_add_f32 v8, v8, v5
    v_add_f32 v9, v9, v6
    v_lshlrev_b32 v5, 16, v53
    v_and_b32 v6, v4, v53
    v_add_f32 v10, v10, v5
    v_add_f32 v11, v11, v6
    v_lshlrev_b32 v5, 16, v54
    v_and_b32 v6, v4, v54
    v_add_f32 v12, v12, v5
    v_add_f32 v13, v13, v6
    v_lshlrev_b32 v5, 16, v55
    v_and_b32 v6, v4, v55
    v_add_f32 v14, v14, v5
    v_add_f32 v15, v15, v6
    s_waitcnt vmcnt(5)
    v_lshlrev_b32 v5, 16, v56
    v_and_b32 v6, v4, v56
    v_add_f32 v8, v8, v5
    v_add_f32 v9, v9, v6
    v_lshlrev_b32 v5, 16, v57
    v_and_b32 v6, v4, v57
    v_add_f32 v10, v10, v5
    v_add_f32 v11, v11, v6
    v_lshlrev_b32 v5, 16, v58
    v_and_b32 v6, v4, v58
    v_add_f32 v12, v12, v5
    v_add_f32 v13, v13, v6
    v_lshlrev_b32 v5, 16, v59
    v_and_b32 v6, v4, v59
    v_add_f32 v14, v14, v5
    v_add_f32 v15, v15, v6
    s_waitcnt vmcnt(4)
    v_lshlrev_b32 v5, 16, v60
    v_and_b32 v6, v4, v60
    v_add_f32 v8, v8, v5
    v_add_f32 v9, v9, v6
    v_lshlrev_b32 v5, 16, v61
    v_and_b32 v6, v4, v61
    v_add_f32 v10, v10, v5
    v_add_f32 v11, v11, v6
    v_lshlrev_b32 v5, 16, v62
    v_and_b32 v6, v4, v62
    v_add_f32 v12, v12, v5
    v_add_f32 v13, v13, v6
    v_lshlrev_b32 v5, 16, v63
    v_and_b32 v6, v4, v63
    v_add_f32 v14, v14, v5
    v_add_f32 v15, v15, v6
    s_waitcnt vmcnt(3)
    v_lshlrev_b32 v5, 16, v64
    v_and_b32 v6, v4, v64
    v_add_f32 v8, v8, v5
    v_add_f32 v9, v9, v6
    v_lshlrev_b32 v5, 16, v65
    v_and_b32 v6, v4, v65
    v_add_f32 v10, v10, v5
    v_add_f32 v11, v11, v6
    v_lshlrev_b32 v5, 16, v66
    v_and_b32 v6, v4, v66
    v_add_f32 v12, v12, v5
    v_add_f32 v13, v13, v6
    v_lshlrev_b32 v5, 16, v67
    v_and_b32 v6, v4, v67
    v_add_f32 v14, v14, v5
    v_add_f32 v15, v15, v6
    s_waitcnt vmcnt(2)
    v_lshlrev_b32 v5, 16, v68
    v_and_b32 v6, v4, v68
    v_add_f32 v8, v8, v5
    v_add_f32 v9, v9, v6
    v_lshlrev_b32 v5, 16, v69
    v_and_b32 v6, v4, v69
    v_add_f32 v10, v10, v5
    v_add_f32 v11, v11, v6
    v_lshlrev_b32 v5, 16, v70
    v_and_b32 v6, v4, v70
    v_add_f32 v12, v12, v5
    v_add_f32 v13, v13, v6
    v_lshlrev_b32 v5, 16, v71
    v_and_b32 v6, v4, v71
    v_add_f32 v14, v14, v5
    v_add_f32 v15, v15, v6
    s_waitcnt vmcnt(1)
    v_lshlrev_b32 v5, 16, v72
    v_and_b32 v6, v4, v72
    v_add_f32 v8, v8, v5
    v_add_f32 v9, v9, v6
    v_lshlrev_b32 v5, 16, v73
    v_and_b32 v6, v4, v73
    v_add_f32 v10, v10, v5
    v_add_f32 v11, v11, v6
    v_lshlrev_b32 v5, 16, v74
    v_and_b32 v6, v4, v74
    v_add_f32 v12, v12, v5
    v_add_f32 v13, v13, v6
    v_lshlrev_b32 v5, 16, v75
    v_and_b32 v6, v4, v75
    v_add_f32 v14, v14, v5
    v_add_f32 v15, v15, v6
    s_waitcnt vmcnt(0)
    v_lshlrev_b32 v5, 16, v76
    v_and_b32 v6, v4, v76
    v_add_f32 v8, v8, v5
    v_add_f32 v9, v9, v6
    v_lshlrev_b32 v5, 16, v77
    v_and_b32 v6, v4, v77
    v_add_f32 v10, v10, v5
    v_add_f32 v11, v11, v6
    v_lshlrev_b32 v5, 16, v78
    v_and_b32 v6, v4, v78
    v_add_f32 v12, v12, v5
    v_add_f32 v13, v13, v6
    v_lshlrev_b32 v5, 16, v79
    v_and_b32 v6, v4, v79
    v_add_f32 v14, v14, v5
    v_add_f32 v15, v15, v6
    v_lshlrev_b32 v5, 5, v0
    ds_write_b128 v5, v[8:11]
    ds_write_b128 v5, v[12:15] offset:16
    s_waitcnt lgkmcnt(0)
    s_barrier
    v_cmp_gt_u32 vcc, 128, v0
    s_and_saveexec_b64 s[36:37], vcc
    s_cbranch_execz L_k0_ln_kernel_end_1
    v_lshlrev_b32 v5, 2, v0
    ds_read_b32 v16, v5 offset:0
    ds_read_b32 v17, v5 offset:512
    ds_read_b32 v18, v5 offset:1024
    ds_read_b32 v19, v5 offset:1536
    ds_read_b32 v20, v5 offset:2048
    ds_read_b32 v21, v5 offset:2560
    ds_read_b32 v22, v5 offset:3072
    ds_read_b32 v23, v5 offset:3584
    ds_read_b32 v24, v5 offset:4096
    ds_read_b32 v25, v5 offset:4608
    ds_read_b32 v26, v5 offset:5120
    ds_read_b32 v27, v5 offset:5632
    ds_read_b32 v28, v5 offset:6144
    ds_read_b32 v29, v5 offset:6656
    ds_read_b32 v30, v5 offset:7168
    ds_read_b32 v31, v5 offset:7680
    s_waitcnt lgkmcnt(0)
    v_add_f32 v16, v16, v17
    v_add_f32 v16, v16, v18
    v_add_f32 v16, v16, v19
    v_add_f32 v16, v16, v20
    v_add_f32 v16, v16, v21
    v_add_f32 v16, v16, v22
    v_add_f32 v16, v16, v23
    v_add_f32 v16, v16, v24
    v_add_f32 v16, v16, v25
    v_add_f32 v16, v16, v26
    v_add_f32 v16, v16, v27
    v_add_f32 v16, v16, v28
    v_add_f32 v16, v16, v29
    v_add_f32 v16, v16, v30
    v_add_f32 v16, v16, v31
    s_mul_i32 s35, s32, 28672
    s_add_u32 s35, s35, s38
    s_lshl_b32 s36, s33, 9
    s_add_u32 s35, s35, s36
    v_add_u32 v5, s35, v5
    buffer_store_dword v16, v5, s[12:15], 0 offen
    s_branch L_k0_ln_kernel_end_1
L_k0_ln_kernel_ln_2:
    s_mov_b32 s8, s4
    s_and_b32 s9, s5, 0xffff
    s_mov_b32 s10, 0x400000
    s_mov_b32 s11, 0x00020000
    s_mov_b32 s12, s20
    s_and_b32 s13, s21, 0xffff
    s_mov_b32 s14, 0x400000
    s_mov_b32 s15, 0x00020000
    s_mov_b32 s24, s6
    s_and_b32 s25, s7, 0xffff
    s_mov_b32 s26, 0x600000
    s_mov_b32 s27, 0x00020000
    s_mov_b32 s28, s64
    s_and_b32 s29, s65, 0xffff
    s_mov_b32 s30, 0x200000
    s_mov_b32 s31, 0x00020000
    v_lshrrev_b32 v62, 6, v0
    v_and_b32 v2, 63, v0
    s_lshl_b32 s3, s2, 3
    v_lshlrev_b32 v3, 1, v62
    v_add_u32 v3, s3, v3
    v_lshlrev_b32 v3, 11, v3
    v_lshl_add_u32 v1, v2, 4, v3
    buffer_load_dwordx4 v[4:7], v1, s[8:11], 0 offen offset:0
    buffer_load_dwordx4 v[8:11], v1, s[8:11], 0 offen offset:1024
    buffer_load_dwordx4 v[12:15], v1, s[8:11], 0 offen offset:2048
    buffer_load_dwordx4 v[16:19], v1, s[8:11], 0 offen offset:3072
    v_lshrrev_b32 v61, 1, v3
    v_mul_u32_u24 v3, 3, v61
    v_lshl_add_u32 v3, v2, 7, v3
    buffer_load_dword v64, v3, s[24:27], 0 offen
    v_lshl_add_u32 v3, v2, 5, v61
    buffer_load_dword v65, v3, s[28:31], 0 offen
    v_mov_b32 v60, 0xffff0000
    v_and_b32 v63, 7, v2
    s_waitcnt vmcnt(4)
    v_lshlrev_b32 v24, 16, v4
    v_and_b32 v25, v60, v4
    v_lshlrev_b32 v26, 16, v5
    v_and_b32 v27, v60, v5
    v_lshlrev_b32 v28, 16, v6
    v_and_b32 v29, v60, v6
    v_lshlrev_b32 v30, 16, v7
    v_and_b32 v31, v60, v7
    v_lshlrev_b32 v32, 16, v8
    v_and_b32 v33, v60, v8
    v_lshlrev_b32 v34, 16, v9
    v_and_b32 v35, v60, v9
    v_lshlrev_b32 v36, 16, v10
    v_and_b32 v37, v60, v10
    v_lshlrev_b32 v38, 16, v11
    v_and_b32 v39, v60, v11
    v_add_f32 v40, v24, v25
    v_add_f32 v40, v40, v26
    v_add_f32 v40, v40, v27
    v_add_f32 v40, v40, v28
    v_add_f32 v40, v40, v29
    v_add_f32 v40, v40, v30
    v_add_f32 v40, v40, v31
    v_add_f32 v40, v40, v32
    v_add_f32 v40, v40, v33
    v_add_f32 v40, v40, v34
    v_add_f32 v40, v40, v35
    v_add_f32 v40, v40, v36
    v_add_f32 v40, v40, v37
    v_add_f32 v40, v40, v38
    v_add_f32 v40, v40, v39
    s_nop 1
    v_add_f32_dpp v40, v40, v40 quad_perm:[1,0,3,2] row_mask:0xf bank_mask:0xf
    s_nop 1
    v_add_f32_dpp v40, v40, v40 quad_perm:[2,3,0,1] row_mask:0xf bank_mask:0xf
    s_nop 1
    v_add_f32_dpp v40, v40, v40 row_half_mirror row_mask:0xf bank_mask:0xf
    s_nop 1
    v_add_f32_dpp v40, v40, v40 row_mirror row_mask:0xf bank_mask:0xf
    s_nop 1
    v_readlane_b32 s16, v40, 0
    v_readlane_b32 s17, v40, 16
    v_readlane_b32 s18, v40, 32
    v_readlane_b32 s19, v40, 48
    s_nop 1
    v_mov_b32 v40, s16
    v_add_f32 v40, s17, v40
    v_add_f32 v40, s18, v40
    v_add_f32 v40, s19, v40
    v_mul_f32 v40, 0x3a800000, v40
    v_mov_b32 v41, 0
    v_sub_f32 v42, v24, v40
    v_fmac_f32 v41, v42, v42
    v_sub_f32 v42, v25, v40
    v_fmac_f32 v41, v42, v42
    v_sub_f32 v42, v26, v40
    v_fmac_f32 v41, v42, v42
    v_sub_f32 v42, v27, v40
    v_fmac_f32 v41, v42, v42
    v_sub_f32 v42, v28, v40
    v_fmac_f32 v41, v42, v42
    v_sub_f32 v42, v29, v40
    v_fmac_f32 v41, v42, v42
    v_sub_f32 v42, v30, v40
    v_fmac_f32 v41, v42, v42
    v_sub_f32 v42, v31, v40
    v_fmac_f32 v41, v42, v42
    v_sub_f32 v42, v32, v40
    v_fmac_f32 v41, v42, v42
    v_sub_f32 v42, v33, v40
    v_fmac_f32 v41, v42, v42
    v_sub_f32 v42, v34, v40
    v_fmac_f32 v41, v42, v42
    v_sub_f32 v42, v35, v40
    v_fmac_f32 v41, v42, v42
    v_sub_f32 v42, v36, v40
    v_fmac_f32 v41, v42, v42
    v_sub_f32 v42, v37, v40
    v_fmac_f32 v41, v42, v42
    v_sub_f32 v42, v38, v40
    v_fmac_f32 v41, v42, v42
    v_sub_f32 v42, v39, v40
    v_fmac_f32 v41, v42, v42
    s_nop 1
    v_add_f32_dpp v41, v41, v41 quad_perm:[1,0,3,2] row_mask:0xf bank_mask:0xf
    s_nop 1
    v_add_f32_dpp v41, v41, v41 quad_perm:[2,3,0,1] row_mask:0xf bank_mask:0xf
    s_nop 1
    v_add_f32_dpp v41, v41, v41 row_half_mirror row_mask:0xf bank_mask:0xf
    s_nop 1
    v_add_f32_dpp v41, v41, v41 row_mirror row_mask:0xf bank_mask:0xf
    s_nop 1
    v_readlane_b32 s16, v41, 0
    v_readlane_b32 s17, v41, 16
    v_readlane_b32 s18, v41, 32
    v_readlane_b32 s19, v41, 48
    s_nop 1
    v_mov_b32 v41, s16
    v_add_f32 v41, s17, v41
    v_add_f32 v41, s18, v41
    v_add_f32 v41, s19, v41
    v_mul_f32 v41, 0x3a800000, v41
    v_cvt_pk_bf16_f32 v40, v40, v40
    v_lshlrev_b32 v40, 16, v40
    v_cvt_pk_bf16_f32 v41, v41, v41
    v_lshlrev_b32 v41, 16, v41
    v_add_f32 v41, 0x3727c5ac, v41
    v_cvt_pk_bf16_f32 v41, v41, v41
    v_lshlrev_b32 v41, 16, v41
    v_sqrt_f32 v41, v41
    s_nop 0
    v_cvt_pk_bf16_f32 v41, v41, v41
    v_lshlrev_b32 v41, 16, v41
    v_rcp_f32 v41, v41
    s_nop 0
    v_sub_f32 v42, v24, v40
    v_sub_f32 v43, v25, v40
    v_cvt_pk_bf16_f32 v42, v42, v43
    v_and_b32 v43, v60, v42
    v_lshlrev_b32 v42, 16, v42
    v_mul_f32 v42, v42, v41
    v_mul_f32 v43, v43, v41
    v_cvt_pk_bf16_f32 v44, v42, v43
    v_sub_f32 v42, v26, v40
    v_sub_f32 v43, v27, v40
    v_cvt_pk_bf16_f32 v42, v42, v43
    v_and_b32 v43, v60, v42
    v_lshlrev_b32 v42, 16, v42
    v_mul_f32 v42, v42, v41
    v_mul_f32 v43, v43, v41
    v_cvt_pk_bf16_f32 v45, v42, v43
    v_sub_f32 v42, v28, v40
    v_sub_f32 v43, v29, v40
    v_cvt_pk_bf16_f32 v42, v42, v43
    v_and_b32 v43, v60, v42
    v_lshlrev_b32 v42, 16, v42
    v_mul_f32 v42, v42, v41
    v_mul_f32 v43, v43, v41
    v_cvt_pk_bf16_f32 v46, v42, v43
    v_sub_f32 v42, v30, v40
    v_sub_f32 v43, v31, v40
    v_cvt_pk_bf16_f32 v42, v42, v43
    v_and_b32 v43, v60, v42
    v_lshlrev_b32 v42, 16, v42
    v_mul_f32 v42, v42, v41
    v_mul_f32 v43, v43, v41
    v_cvt_pk_bf16_f32 v47, v42, v43
    v_sub_f32 v42, v32, v40
    v_sub_f32 v43, v33, v40
    v_cvt_pk_bf16_f32 v42, v42, v43
    v_and_b32 v43, v60, v42
    v_lshlrev_b32 v42, 16, v42
    v_mul_f32 v42, v42, v41
    v_mul_f32 v43, v43, v41
    v_cvt_pk_bf16_f32 v48, v42, v43
    v_sub_f32 v42, v34, v40
    v_sub_f32 v43, v35, v40
    v_cvt_pk_bf16_f32 v42, v42, v43
    v_and_b32 v43, v60, v42
    v_lshlrev_b32 v42, 16, v42
    v_mul_f32 v42, v42, v41
    v_mul_f32 v43, v43, v41
    v_cvt_pk_bf16_f32 v49, v42, v43
    v_sub_f32 v42, v36, v40
    v_sub_f32 v43, v37, v40
    v_cvt_pk_bf16_f32 v42, v42, v43
    v_and_b32 v43, v60, v42
    v_lshlrev_b32 v42, 16, v42
    v_mul_f32 v42, v42, v41
    v_mul_f32 v43, v43, v41
    v_cvt_pk_bf16_f32 v50, v42, v43
    v_sub_f32 v42, v38, v40
    v_sub_f32 v43, v39, v40
    v_cvt_pk_bf16_f32 v42, v42, v43
    v_and_b32 v43, v60, v42
    v_lshlrev_b32 v42, 16, v42
    v_mul_f32 v42, v42, v41
    v_mul_f32 v43, v43, v41
    v_cvt_pk_bf16_f32 v51, v42, v43
    v_lshl_add_u32 v42, v62, 1, 0
    v_xor_b32 v42, v42, v63
    v_lshlrev_b32 v42, 4, v42
    v_lshl_add_u32 v42, v2, 7, v42
    ds_write_b128 v42, v[44:47]
    ds_write_b128 v42, v[48:51] offset:8192
    s_waitcnt vmcnt(2)
    v_lshlrev_b32 v24, 16, v12
    v_and_b32 v25, v60, v12
    v_lshlrev_b32 v26, 16, v13
    v_and_b32 v27, v60, v13
    v_lshlrev_b32 v28, 16, v14
    v_and_b32 v29, v60, v14
    v_lshlrev_b32 v30, 16, v15
    v_and_b32 v31, v60, v15
    v_lshlrev_b32 v32, 16, v16
    v_and_b32 v33, v60, v16
    v_lshlrev_b32 v34, 16, v17
    v_and_b32 v35, v60, v17
    v_lshlrev_b32 v36, 16, v18
    v_and_b32 v37, v60, v18
    v_lshlrev_b32 v38, 16, v19
    v_and_b32 v39, v60, v19
    v_add_f32 v40, v24, v25
    v_add_f32 v40, v40, v26
    v_add_f32 v40, v40, v27
    v_add_f32 v40, v40, v28
    v_add_f32 v40, v40, v29
    v_add_f32 v40, v40, v30
    v_add_f32 v40, v40, v31
    v_add_f32 v40, v40, v32
    v_add_f32 v40, v40, v33
    v_add_f32 v40, v40, v34
    v_add_f32 v40, v40, v35
    v_add_f32 v40, v40, v36
    v_add_f32 v40, v40, v37
    v_add_f32 v40, v40, v38
    v_add_f32 v40, v40, v39
    s_nop 1
    v_add_f32_dpp v40, v40, v40 quad_perm:[1,0,3,2] row_mask:0xf bank_mask:0xf
    s_nop 1
    v_add_f32_dpp v40, v40, v40 quad_perm:[2,3,0,1] row_mask:0xf bank_mask:0xf
    s_nop 1
    v_add_f32_dpp v40, v40, v40 row_half_mirror row_mask:0xf bank_mask:0xf
    s_nop 1
    v_add_f32_dpp v40, v40, v40 row_mirror row_mask:0xf bank_mask:0xf
    s_nop 1
    v_readlane_b32 s16, v40, 0
    v_readlane_b32 s17, v40, 16
    v_readlane_b32 s18, v40, 32
    v_readlane_b32 s19, v40, 48
    s_nop 1
    v_mov_b32 v40, s16
    v_add_f32 v40, s17, v40
    v_add_f32 v40, s18, v40
    v_add_f32 v40, s19, v40
    v_mul_f32 v40, 0x3a800000, v40
    v_mov_b32 v41, 0
    v_sub_f32 v42, v24, v40
    v_fmac_f32 v41, v42, v42
    v_sub_f32 v42, v25, v40
    v_fmac_f32 v41, v42, v42
    v_sub_f32 v42, v26, v40
    v_fmac_f32 v41, v42, v42
    v_sub_f32 v42, v27, v40
    v_fmac_f32 v41, v42, v42
    v_sub_f32 v42, v28, v40
    v_fmac_f32 v41, v42, v42
    v_sub_f32 v42, v29, v40
    v_fmac_f32 v41, v42, v42
    v_sub_f32 v42, v30, v40
    v_fmac_f32 v41, v42, v42
    v_sub_f32 v42, v31, v40
    v_fmac_f32 v41, v42, v42
    v_sub_f32 v42, v32, v40
    v_fmac_f32 v41, v42, v42
    v_sub_f32 v42, v33, v40
    v_fmac_f32 v41, v42, v42
    v_sub_f32 v42, v34, v40
    v_fmac_f32 v41, v42, v42
    v_sub_f32 v42, v35, v40
    v_fmac_f32 v41, v42, v42
    v_sub_f32 v42, v36, v40
    v_fmac_f32 v41, v42, v42
    v_sub_f32 v42, v37, v40
    v_fmac_f32 v41, v42, v42
    v_sub_f32 v42, v38, v40
    v_fmac_f32 v41, v42, v42
    v_sub_f32 v42, v39, v40
    v_fmac_f32 v41, v42, v42
    s_nop 1
    v_add_f32_dpp v41, v41, v41 quad_perm:[1,0,3,2] row_mask:0xf bank_mask:0xf
    s_nop 1
    v_add_f32_dpp v41, v41, v41 quad_perm:[2,3,0,1] row_mask:0xf bank_mask:0xf
    s_nop 1
    v_add_f32_dpp v41, v41, v41 row_half_mirror row_mask:0xf bank_mask:0xf
    s_nop 1
    v_add_f32_dpp v41, v41, v41 row_mirror row_mask:0xf bank_mask:0xf
    s_nop 1
    v_readlane_b32 s16, v41, 0
    v_readlane_b32 s17, v41, 16
    v_readlane_b32 s18, v41, 32
    v_readlane_b32 s19, v41, 48
    s_nop 1
    v_mov_b32 v41, s16
    v_add_f32 v41, s17, v41
    v_add_f32 v41, s18, v41
    v_add_f32 v41, s19, v41
    v_mul_f32 v41, 0x3a800000, v41
    v_cvt_pk_bf16_f32 v40, v40, v40
    v_lshlrev_b32 v40, 16, v40
    v_cvt_pk_bf16_f32 v41, v41, v41
    v_lshlrev_b32 v41, 16, v41
    v_add_f32 v41, 0x3727c5ac, v41
    v_cvt_pk_bf16_f32 v41, v41, v41
    v_lshlrev_b32 v41, 16, v41
    v_sqrt_f32 v41, v41
    s_nop 0
    v_cvt_pk_bf16_f32 v41, v41, v41
    v_lshlrev_b32 v41, 16, v41
    v_rcp_f32 v41, v41
    s_nop 0
    v_sub_f32 v42, v24, v40
    v_sub_f32 v43, v25, v40
    v_cvt_pk_bf16_f32 v42, v42, v43
    v_and_b32 v43, v60, v42
    v_lshlrev_b32 v42, 16, v42
    v_mul_f32 v42, v42, v41
    v_mul_f32 v43, v43, v41
    v_cvt_pk_bf16_f32 v52, v42, v43
    v_sub_f32 v42, v26, v40
    v_sub_f32 v43, v27, v40
    v_cvt_pk_bf16_f32 v42, v42, v43
    v_and_b32 v43, v60, v42
    v_lshlrev_b32 v42, 16, v42
    v_mul_f32 v42, v42, v41
    v_mul_f32 v43, v43, v41
    v_cvt_pk_bf16_f32 v53, v42, v43
    v_sub_f32 v42, v28, v40
    v_sub_f32 v43, v29, v40
    v_cvt_pk_bf16_f32 v42, v42, v43
    v_and_b32 v43, v60, v42
    v_lshlrev_b32 v42, 16, v42
    v_mul_f32 v42, v42, v41
    v_mul_f32 v43, v43, v41
    v_cvt_pk_bf16_f32 v54, v42, v43
    v_sub_f32 v42, v30, v40
    v_sub_f32 v43, v31, v40
    v_cvt_pk_bf16_f32 v42, v42, v43
    v_and_b32 v43, v60, v42
    v_lshlrev_b32 v42, 16, v42
    v_mul_f32 v42, v42, v41
    v_mul_f32 v43, v43, v41
    v_cvt_pk_bf16_f32 v55, v42, v43
    v_sub_f32 v42, v32, v40
    v_sub_f32 v43, v33, v40
    v_cvt_pk_bf16_f32 v42, v42, v43
    v_and_b32 v43, v60, v42
    v_lshlrev_b32 v42, 16, v42
    v_mul_f32 v42, v42, v41
    v_mul_f32 v43, v43, v41
    v_cvt_pk_bf16_f32 v56, v42, v43
    v_sub_f32 v42, v34, v40
    v_sub_f32 v43, v35, v40
    v_cvt_pk_bf16_f32 v42, v42, v43
    v_and_b32 v43, v60, v42
    v_lshlrev_b32 v42, 16, v42
    v_mul_f32 v42, v42, v41
    v_mul_f32 v43, v43, v41
    v_cvt_pk_bf16_f32 v57, v42, v43
    v_sub_f32 v42, v36, v40
    v_sub_f32 v43, v37, v40
    v_cvt_pk_bf16_f32 v42, v42, v43
    v_and_b32 v43, v60, v42
    v_lshlrev_b32 v42, 16, v42
    v_mul_f32 v42, v42, v41
    v_mul_f32 v43, v43, v41
    v_cvt_pk_bf16_f32 v58, v42, v43
    v_sub_f32 v42, v38, v40
    v_sub_f32 v43, v39, v40
    v_cvt_pk_bf16_f32 v42, v42, v43
    v_and_b32 v43, v60, v42
    v_lshlrev_b32 v42, 16, v42
    v_mul_f32 v42, v42, v41
    v_mul_f32 v43, v43, v41
    v_cvt_pk_bf16_f32 v59, v42, v43
    v_lshl_add_u32 v42, v62, 1, 1
    v_xor_b32 v42, v42, v63
    v_lshlrev_b32 v42, 4, v42
    v_lshl_add_u32 v42, v2, 7, v42
    ds_write_b128 v42, v[52:55]
    ds_write_b128 v42, v[56:59] offset:8192
    s_waitcnt lgkmcnt(0)
    s_barrier
    v_and_b32 v4, 7, v0
    v_lshrrev_b32 v5, 3, v0
    v_and_b32 v6, 7, v5
    v_xor_b32 v6, v6, v4
    v_lshlrev_b32 v6, 4, v6
    v_lshl_add_u32 v6, v5, 7, v6
    ds_read_b128 v[8:11], v6 offset:0
    ds_read_b128 v[12:15], v6 offset:4096
    ds_read_b128 v[16:19], v6 offset:8192
    ds_read_b128 v[20:23], v6 offset:12288
    s_lshr_b32 s16, s2, 2
    s_lshl_b32 s16, s16, 16
    s_and_b32 s17, s2, 3
    s_lshl_b32 s17, s17, 7
    s_add_u32 s16, s16, s17
    v_lshlrev_b32 v7, 9, v5
    v_lshl_add_u32 v7, v4, 4, v7
    v_add_u32 v7, s16, v7
    s_mov_b32 s17, 0
    s_waitcnt lgkmcnt(3)
    buffer_store_dwordx4 v[8:11], v7, s[12:15], s17 offen sc1
    s_add_u32 s17, s17, 16384
    s_waitcnt lgkmcnt(2)
    buffer_store_dwordx4 v[12:15], v7, s[12:15], s17 offen sc1
    s_add_u32 s17, s17, 16384
    s_waitcnt lgkmcnt(1)
    buffer_store_dwordx4 v[16:19], v7, s[12:15], s17 offen sc1
    s_add_u32 s17, s17, 16384
    s_waitcnt lgkmcnt(0)
    buffer_store_dwordx4 v[20:23], v7, s[12:15], s17 offen sc1
    s_add_u32 s17, s17, 16384
L_k0_ln_kernel_end_1:
    s_endpgm
.globl k1_qkv_kernel
.p2align 8
.type k1_qkv_kernel,@function
k1_qkv_kernel:
    s_cmp_ge_u32 s2, 256
    s_cbranch_scc1 L_k1_qkv_kernel_end_1
    s_load_dwordx2 s[4:5], s[0:1], 8
    s_load_dwordx2 s[6:7], s[0:1], 72
    s_and_b32 s20, s2, 7
    s_lshr_b32 s21, s2, 3
    s_and_b32 s22, s20, 3
    s_lshl_b32 s22, s22, 2
    s_and_b32 s23, s21, 3
    s_add_u32 s22, s22, s23
    s_lshr_b32 s23, s20, 2
    s_lshl_b32 s23, s23, 3
    s_lshr_b32 s24, s21, 2
    s_add_u32 s23, s23, s24
    v_lshrrev_b32 v1, 6, v0
    v_and_b32 v2, 63, v0
    s_nop 0
    v_readfirstlane_b32 s25, v1
    s_lshr_b32 s27, s25, 1
    s_and_b32 s28, s25, 1
    v_lshlrev_b32 v9, 4, v2
    s_lshl_b32 s30, s23, 2
    s_lshr_b32 s31, s25, 1
    s_add_u32 s30, s30, s31
    s_lshl_b32 s30, s30, 6
    s_lshl_b32 s31, s28, 1
    s_add_u32 s30, s30, s31
    s_lshl_b32 s30, s30, 10
    v_add_u32 v10, s30, v9
    v_add_u32 v11, 1024, v10
    s_lshl_b32 s40, s25, 11
    s_add_u32 s40, s40, 0
    s_lshl_b32 s41, s25, 11
    s_add_u32 s41, s41, 1024
    s_mul_i32 s30, s25, 12
    s_add_u32 s30, s30, 0
    v_lshrrev_b32 v3, 4, v2
    v_add_u32 v3, s30, v3
    v_mul_u32_u24 v4, 43, v3
    v_lshrrev_b32 v4, 8, v4
    v_mul_u32_u24 v5, 6, v4
    v_sub_u32 v5, v3, v5
    v_bfe_u32 v6, v2, 2, 2
    v_lshl_add_u32 v6, v4, 2, v6
    v_mul_u32_u24 v6, 6144, v6
    v_lshrrev_b32 v7, 1, v5
    v_lshl_add_u32 v6, v7, 11, v6
    v_and_b32 v7, 1, v5
    v_lshl_add_u32 v6, v7, 6, v6
    v_and_b32 v7, 3, v2
    v_lshl_add_u32 v6, v7, 4, v6
    s_lshl_b32 s31, s22, 7
    v_add_u32 v12, s31, v6
    s_mul_i32 s42, s25, 3072
    s_add_u32 s42, s42, 16384
    s_mul_i32 s30, s25, 12
    s_add_u32 s30, s30, 4
    v_lshrrev_b32 v3, 4, v2
    v_add_u32 v3, s30, v3
    v_mul_u32_u24 v4, 43, v3
    v_lshrrev_b32 v4, 8, v4
    v_mul_u32_u24 v5, 6, v4
    v_sub_u32 v5, v3, v5
    v_bfe_u32 v6, v2, 2, 2
    v_lshl_add_u32 v6, v4, 2, v6
    v_mul_u32_u24 v6, 6144, v6
    v_lshrrev_b32 v7, 1, v5
    v_lshl_add_u32 v6, v7, 11, v6
    v_and_b32 v7, 1, v5
    v_lshl_add_u32 v6, v7, 6, v6
    v_and_b32 v7, 3, v2
    v_lshl_add_u32 v6, v7, 4, v6
    s_lshl_b32 s31, s22, 7
    v_add_u32 v13, s31, v6
    s_mul_i32 s43, s25, 3072
    s_add_u32 s43, s43, 17408
    s_mul_i32 s30, s25, 12
    s_add_u32 s30, s30, 8
    v_lshrrev_b32 v3, 4, v2
    v_add_u32 v3, s30, v3
    v_mul_u32_u24 v4, 43, v3
    v_lshrrev_b32 v4, 8, v4
    v_mul_u32_u24 v5, 6, v4
    v_sub_u32 v5, v3, v5
    v_bfe_u32 v6, v2, 2, 2
    v_lshl_add_u32 v6, v4, 2, v6
    v_mul_u32_u24 v6, 6144, v6
    v_lshrrev_b32 v7, 1, v5
    v_lshl_add_u32 v6, v7, 11, v6
    v_and_b32 v7, 1, v5
    v_lshl_add_u32 v6, v7, 6, v6
    v_and_b32 v7, 3, v2
    v_lshl_add_u32 v6, v7, 4, v6
    s_lshl_b32 s31, s22, 7
    v_add_u32 v14, s31, v6
    s_mul_i32 s44, s25, 3072
    s_add_u32 s44, s44, 18432
    s_mov_b32 s50, 0
    s_mov_b32 s51, 0
    s_waitcnt lgkmcnt(0)
    s_mov_b32 s8, s6
    s_and_b32 s9, s7, 0xffff
    s_mov_b32 s10, 0x400000
    s_mov_b32 s11, 0x00020000
    s_mov_b32 s12, s4
    s_and_b32 s13, s5, 0xffff
    s_mov_b32 s14, 0x600000
    s_mov_b32 s15, 0x00020000
    s_mov_b32 s52, 0
    s_mov_b32 s53, 0
    s_add_u32 m0, s52, s40
    s_nop 0
    buffer_load_dwordx4 v10, s[8:11], s50 offen lds
    s_add_u32 m0, s52, s41
    s_nop 0
    buffer_load_dwordx4 v11, s[8:11], s50 offen lds
    s_add_u32 m0, s52, s42
    s_nop 0
    buffer_load_dwordx4 v12, s[12:15], s51 offen lds
    s_add_u32 m0, s52, s43
    s_nop 0
    buffer_load_dwordx4 v13, s[12:15], s51 offen lds
    s_add_u32 m0, s52, s44
    s_nop 0
    buffer_load_dwordx4 v14, s[12:15], s51 offen lds
    s_add_u32 s50, s50, 0x1000
    s_add_u32 s51, s51, 0x60000
    s_add_u32 s52, s52, 40960
    s_cmp_ge_u32 s52, 163840
    s_cselect_b32 s52, 0, s52
    s_add_u32 m0, s52, s40
    s_nop 0
    buffer_load_dwordx4 v10, s[8:11], s50 offen lds
    s_add_u32 m0, s52, s41
    s_nop 0
    buffer_load_dwordx4 v11, s[8:11], s50 offen lds
    s_add_u32 m0, s52, s42
    s_nop 0
    buffer_load_dwordx4 v12, s[12:15], s51 offen lds
    s_add_u32 m0, s52, s43
    s_nop 0
    buffer_load_dwordx4 v13, s[12:15], s51 offen lds
    s_add_u32 m0, s52, s44
    s_nop 0
    buffer_load_dwordx4 v14, s[12:15], s51 offen lds
    s_add_u32 s50, s50, 0x1000
    s_add_u32 s51, s51, 0x60000
    s_add_u32 s52, s52, 40960
    s_cmp_ge_u32 s52, 163840
    s_cselect_b32 s52, 0, s52
    s_add_u32 m0, s52, s40
    s_nop 0
    buffer_load_dwordx4 v10, s[8:11], s50 offen lds
    s_add_u32 m0, s52, s41
    s_nop 0
    buffer_load_dwordx4 v11, s[8:11], s50 offen lds
    s_add_u32 m0, s52, s42
    s_nop 0
    buffer_load_dwordx4 v12, s[12:15], s51 offen lds
    s_add_u32 m0, s52, s43
    s_nop 0
    buffer_load_dwordx4 v13, s[12:15], s51 offen lds
    s_add_u32 m0, s52, s44
    s_nop 0
    buffer_load_dwordx4 v14, s[12:15], s51 offen lds
    s_add_u32 s50, s50, 0x1000
    s_add_u32 s51, s51, 0x60000
    s_add_u32 s52, s52, 40960
    s_cmp_ge_u32 s52, 163840
    s_cselect_b32 s52, 0, s52
    s_lshl_b32 s30, s27, 12
    v_add_u32 v16, s30, v9
    v_bfe_u32 v3, v2, 2, 2
    v_lshlrev_b32 v3, 6, v3
    v_bfe_u32 v4, v2, 4, 1
    v_lshl_add_u32 v3, v4, 5, v3
    v_and_b32 v4, 3, v2
    v_lshl_add_u32 v3, v4, 3, v3
    v_lshrrev_b32 v4, 5, v2
    v_mul_u32_u24 v4, 3072, v4
    v_add_u32 v3, v3, v4
    s_lshl_b32 s31, s28, 8
    s_add_u32 s30, s31, 16384
    v_add_u32 v18, s30, v3
    v_mov_b32 v32, 0
    v_mov_b32 v33, 0
    v_mov_b32 v34, 0
    v_mov_b32 v35, 0
    v_mov_b32 v36, 0
    v_mov_b32 v37, 0
    v_mov_b32 v38, 0
    v_mov_b32 v39, 0
    v_mov_b32 v40, 0
    v_mov_b32 v41, 0
    v_mov_b32 v42, 0
    v_mov_b32 v43, 0
    v_mov_b32 v44, 0
    v_mov_b32 v45, 0
    v_mov_b32 v46, 0
    v_mov_b32 v47, 0
    v_mov_b32 v48, 0
    v_mov_b32 v49, 0
    v_mov_b32 v50, 0
    v_mov_b32 v51, 0
    v_mov_b32 v52, 0
    v_mov_b32 v53, 0
    v_mov_b32 v54, 0
    v_mov_b32 v55, 0
    v_mov_b32 v56, 0
    v_mov_b32 v57, 0
    v_mov_b32 v58, 0
    v_mov_b32 v59, 0
    v_mov_b32 v60, 0
    v_mov_b32 v61, 0
    v_mov_b32 v62, 0
    v_mov_b32 v63, 0
    v_mov_b32 v64, 0
    v_mov_b32 v65, 0
    v_mov_b32 v66, 0
    v_mov_b32 v67, 0
    v_mov_b32 v68, 0
    v_mov_b32 v69, 0
    v_mov_b32 v70, 0
    v_mov_b32 v71, 0
    v_mov_b32 v72, 0
    v_mov_b32 v73, 0
    v_mov_b32 v74, 0
    v_mov_b32 v75, 0
    v_mov_b32 v76, 0
    v_mov_b32 v77, 0
    v_mov_b32 v78, 0
    v_mov_b32 v79, 0
    s_mov_b32 s97, -122880
    s_waitcnt vmcnt(10)
    s_barrier
    ds_read_b128 v[128:131], v16 offset:0
    ds_read_b64_tr_b16 v[136:137], v18 offset:0
    ds_read_b64_tr_b16 v[138:139], v18 offset:1536
    ds_read_b64_tr_b16 v[140:141], v18 offset:512
    ds_read_b64_tr_b16 v[142:143], v18 offset:2048
    ds_read_b64_tr_b16 v[144:145], v18 offset:1024
    ds_read_b64_tr_b16 v[146:147], v18 offset:2560
    s_mov_b32 s54, 13
L_k1_qkv_kernel_loop_2:
    s_waitcnt vmcnt(5)
    s_barrier
    s_waitcnt lgkmcnt(4)
    v_mfma_f32_32x32x16_bf16 v[32:47], v[136:139], v[128:131], v[32:47]
    ds_read_b128 v[148:151], v16 offset:1024
    ds_read_b64_tr_b16 v[156:157], v18 offset:6144
    ds_read_b64_tr_b16 v[158:159], v18 offset:7680
    s_add_u32 m0, s52, s40
    s_nop 0
    buffer_load_dwordx4 v10, s[8:11], s50 offen lds
    s_waitcnt lgkmcnt(5)
    v_mfma_f32_32x32x16_bf16 v[48:63], v[128:131], v[140:143], v[48:63]
    ds_read_b64_tr_b16 v[160:161], v18 offset:6656
    ds_read_b64_tr_b16 v[162:163], v18 offset:8192
    s_add_u32 m0, s52, s41
    s_nop 0
    buffer_load_dwordx4 v11, s[8:11], s50 offen lds
    s_waitcnt lgkmcnt(5)
    v_mfma_f32_32x32x16_bf16 v[64:79], v[128:131], v[144:147], v[64:79]
    ds_read_b64_tr_b16 v[164:165], v18 offset:7168
    ds_read_b64_tr_b16 v[166:167], v18 offset:8704
    s_add_u32 m0, s52, s42
    s_nop 0
    buffer_load_dwordx4 v12, s[12:15], s51 offen lds
    s_waitcnt lgkmcnt(4)
    v_mfma_f32_32x32x16_bf16 v[32:47], v[156:159], v[148:151], v[32:47]
    ds_read_b128 v[128:131], v16 offset:2048
    ds_read_b64_tr_b16 v[136:137], v18 offset:12288
    ds_read_b64_tr_b16 v[138:139], v18 offset:13824
    s_add_u32 m0, s52, s43
    s_nop 0
    buffer_load_dwordx4 v13, s[12:15], s51 offen lds
    s_waitcnt lgkmcnt(5)
    v_mfma_f32_32x32x16_bf16 v[48:63], v[148:151], v[160:163], v[48:63]
    ds_read_b64_tr_b16 v[140:141], v18 offset:12800
    ds_read_b64_tr_b16 v[142:143], v18 offset:14336
    s_add_u32 m0, s52, s44
    s_nop 0
    buffer_load_dwordx4 v14, s[12:15], s51 offen lds
    s_add_u32 s50, s50, 0x1000
    s_add_u32 s51, s51, 0x60000
    s_add_u32 s52, s52, 40960
    s_cmp_ge_u32 s52, 163840
    s_cselect_b32 s52, 0, s52
    s_waitcnt lgkmcnt(5)
    v_mfma_f32_32x32x16_bf16 v[64:79], v[148:151], v[164:167], v[64:79]
    ds_read_b64_tr_b16 v[144:145], v18 offset:13312
    ds_read_b64_tr_b16 v[146:147], v18 offset:14848
    s_waitcnt lgkmcnt(4)
    v_mfma_f32_32x32x16_bf16 v[32:47], v[136:139], v[128:131], v[32:47]
    ds_read_b128 v[148:151], v16 offset:3072
    ds_read_b64_tr_b16 v[156:157], v18 offset:18432
    ds_read_b64_tr_b16 v[158:159], v18 offset:19968
    s_waitcnt lgkmcnt(5)
    v_mfma_f32_32x32x16_bf16 v[48:63], v[128:131], v[140:143], v[48:63]
    ds_read_b64_tr_b16 v[160:161], v18 offset:18944
    ds_read_b64_tr_b16 v[162:163], v18 offset:20480
    s_waitcnt lgkmcnt(5)
    v_mfma_f32_32x32x16_bf16 v[64:79], v[128:131], v[144:147], v[64:79]
    ds_read_b64_tr_b16 v[164:165], v18 offset:19456
    ds_read_b64_tr_b16 v[166:167], v18 offset:20992
    s_add_u32 s53, s53, 40960
    s_cmp_ge_u32 s53, 163840
    s_cselect_b32 s53, 0, s53
    s_cselect_b32 s96, s97, 40960
    v_add_u32 v16, s96, v16
    v_add_u32 v18, s96, v18
    s_waitcnt lgkmcnt(4)
    v_mfma_f32_32x32x16_bf16 v[32:47], v[156:159], v[148:151], v[32:47]
    ds_read_b128 v[128:131], v16 offset:0
    ds_read_b64_tr_b16 v[136:137], v18 offset:0
    ds_read_b64_tr_b16 v[138:139], v18 offset:1536
    s_waitcnt lgkmcnt(5)
    v_mfma_f32_32x32x16_bf16 v[48:63], v[148:151], v[160:163], v[48:63]
    ds_read_b64_tr_b16 v[140:141], v18 offset:512
    ds_read_b64_tr_b16 v[142:143], v18 offset:2048
    s_waitcnt lgkmcnt(5)
    v_mfma_f32_32x32x16_bf16 v[64:79], v[148:151], v[164:167], v[64:79]
    ds_read_b64_tr_b16 v[144:145], v18 offset:1024
    ds_read_b64_tr_b16 v[146:147], v18 offset:2560
    s_sub_u32 s54, s54, 1
    s_cmp_lg_u32 s54, 0
    s_cbranch_scc1 L_k1_qkv_kernel_loop_2
    s_waitcnt vmcnt(5)
    s_barrier
    s_waitcnt lgkmcnt(4)
    v_mfma_f32_32x32x16_bf16 v[32:47], v[136:139], v[128:131], v[32:47]
    ds_read_b128 v[148:151], v16 offset:1024
    ds_read_b64_tr_b16 v[156:157], v18 offset:6144
    ds_read_b64_tr_b16 v[158:159], v18 offset:7680
    s_waitcnt lgkmcnt(5)
    v_mfma_f32_32x32x16_bf16 v[48:63], v[128:131], v[140:143], v[48:63]
    ds_read_b64_tr_b16 v[160:161], v18 offset:6656
    ds_read_b64_tr_b16 v[162:163], v18 offset:8192
    s_waitcnt lgkmcnt(5)
    v_mfma_f32_32x32x16_bf16 v[64:79], v[128:131], v[144:147], v[64:79]
    ds_read_b64_tr_b16 v[164:165], v18 offset:7168
    ds_read_b64_tr_b16 v[166:167], v18 offset:8704
    s_waitcnt lgkmcnt(4)
    v_mfma_f32_32x32x16_bf16 v[32:47], v[156:159], v[148:151], v[32:47]
    ds_read_b128 v[128:131], v16 offset:2048
    ds_read_b64_tr_b16 v[136:137], v18 offset:12288
    ds_read_b64_tr_b16 v[138:139], v18 offset:13824
    s_waitcnt lgkmcnt(5)
    v_mfma_f32_32x32x16_bf16 v[48:63], v[148:151], v[160:163], v[48:63]
    ds_read_b64_tr_b16 v[140:141], v18 offset:12800
    ds_read_b64_tr_b16 v[142:143], v18 offset:14336
    s_waitcnt lgkmcnt(5)
    v_mfma_f32_32x32x16_bf16 v[64:79], v[148:151], v[164:167], v[64:79]
    ds_read_b64_tr_b16 v[144:145], v18 offset:13312
    ds_read_b64_tr_b16 v[146:147], v18 offset:14848
    s_waitcnt lgkmcnt(4)
    v_mfma_f32_32x32x16_bf16 v[32:47], v[136:139], v[128:131], v[32:47]
    ds_read_b128 v[148:151], v16 offset:3072
    ds_read_b64_tr_b16 v[156:157], v18 offset:18432
    ds_read_b64_tr_b16 v[158:159], v18 offset:19968
    s_waitcnt lgkmcnt(5)
    v_mfma_f32_32x32x16_bf16 v[48:63], v[128:131], v[140:143], v[48:63]
    ds_read_b64_tr_b16 v[160:161], v18 offset:18944
    ds_read_b64_tr_b16 v[162:163], v18 offset:20480
    s_waitcnt lgkmcnt(5)
    v_mfma_f32_32x32x16_bf16 v[64:79], v[128:131], v[144:147], v[64:79]
    ds_read_b64_tr_b16 v[164:165], v18 offset:19456
    ds_read_b64_tr_b16 v[166:167], v18 offset:20992
    s_add_u32 s53, s53, 40960
    s_cmp_ge_u32 s53, 163840
    s_cselect_b32 s53, 0, s53
    s_cselect_b32 s96, s97, 40960
    v_add_u32 v16, s96, v16
    v_add_u32 v18, s96, v18
    s_waitcnt lgkmcnt(4)
    v_mfma_f32_32x32x16_bf16 v[32:47], v[156:159], v[148:151], v[32:47]
    ds_read_b128 v[128:131], v16 offset:0
    ds_read_b64_tr_b16 v[136:137], v18 offset:0
    ds_read_b64_tr_b16 v[138:139], v18 offset:1536
    s_waitcnt lgkmcnt(5)
    v_mfma_f32_32x32x16_bf16 v[48:63], v[148:151], v[160:163], v[48:63]
    ds_read_b64_tr_b16 v[140:141], v18 offset:512
    ds_read_b64_tr_b16 v[142:143], v18 offset:2048
    s_waitcnt lgkmcnt(5)
    v_mfma_f32_32x32x16_bf16 v[64:79], v[148:151], v[164:167], v[64:79]
    ds_read_b64_tr_b16 v[144:145], v18 offset:1024
    ds_read_b64_tr_b16 v[146:147], v18 offset:2560
    s_waitcnt vmcnt(0)
    s_barrier
    s_waitcnt lgkmcnt(4)
    v_mfma_f32_32x32x16_bf16 v[32:47], v[136:139], v[128:131], v[32:47]
    ds_read_b128 v[148:151], v16 offset:1024
    ds_read_b64_tr_b16 v[156:157], v18 offset:6144
    ds_read_b64_tr_b16 v[158:159], v18 offset:7680
    s_waitcnt lgkmcnt(5)
    v_mfma_f32_32x32x16_bf16 v[48:63], v[128:131], v[140:143], v[48:63]
    ds_read_b64_tr_b16 v[160:161], v18 offset:6656
    ds_read_b64_tr_b16 v[162:163], v18 offset:8192
    s_waitcnt lgkmcnt(5)
    v_mfma_f32_32x32x16_bf16 v[64:79], v[128:131], v[144:147], v[64:79]
    ds_read_b64_tr_b16 v[164:165], v18 offset:7168
    ds_read_b64_tr_b16 v[166:167], v18 offset:8704
    s_waitcnt lgkmcnt(4)
    v_mfma_f32_32x32x16_bf16 v[32:47], v[156:159], v[148:151], v[32:47]
    ds_read_b128 v[128:131], v16 offset:2048
    ds_read_b64_tr_b16 v[136:137], v18 offset:12288
    ds_read_b64_tr_b16 v[138:139], v18 offset:13824
    s_waitcnt lgkmcnt(5)
    v_mfma_f32_32x32x16_bf16 v[48:63], v[148:151], v[160:163], v[48:63]
    ds_read_b64_tr_b16 v[140:141], v18 offset:12800
    ds_read_b64_tr_b16 v[142:143], v18 offset:14336
    s_waitcnt lgkmcnt(5)
    v_mfma_f32_32x32x16_bf16 v[64:79], v[148:151], v[164:167], v[64:79]
    ds_read_b64_tr_b16 v[144:145], v18 offset:13312
    ds_read_b64_tr_b16 v[146:147], v18 offset:14848
    s_waitcnt lgkmcnt(4)
    v_mfma_f32_32x32x16_bf16 v[32:47], v[136:139], v[128:131], v[32:47]
    ds_read_b128 v[148:151], v16 offset:3072
    ds_read_b64_tr_b16 v[156:157], v18 offset:18432
    ds_read_b64_tr_b16 v[158:159], v18 offset:19968
    s_waitcnt lgkmcnt(5)
    v_mfma_f32_32x32x16_bf16 v[48:63], v[128:131], v[140:143], v[48:63]
    ds_read_b64_tr_b16 v[160:161], v18 offset:18944
    ds_read_b64_tr_b16 v[162:163], v18 offset:20480
    s_waitcnt lgkmcnt(5)
    v_mfma_f32_32x32x16_bf16 v[64:79], v[128:131], v[144:147], v[64:79]
    ds_read_b64_tr_b16 v[164:165], v18 offset:19456
    ds_read_b64_tr_b16 v[166:167], v18 offset:20992
    s_add_u32 s53, s53, 40960
    s_cmp_ge_u32 s53, 163840
    s_cselect_b32 s53, 0, s53
    s_cselect_b32 s96, s97, 40960
    v_add_u32 v16, s96, v16
    v_add_u32 v18, s96, v18
    s_waitcnt lgkmcnt(4)
    v_mfma_f32_32x32x16_bf16 v[32:47], v[156:159], v[148:151], v[32:47]
    ds_read_b128 v[128:131], v16 offset:0
    ds_read_b64_tr_b16 v[136:137], v18 offset:0
    ds_read_b64_tr_b16 v[138:139], v18 offset:1536
    s_waitcnt lgkmcnt(5)
    v_mfma_f32_32x32x16_bf16 v[48:63], v[148:151], v[160:163], v[48:63]
    ds_read_b64_tr_b16 v[140:141], v18 offset:512
    ds_read_b64_tr_b16 v[142:143], v18 offset:2048
    s_waitcnt lgkmcnt(5)
    v_mfma_f32_32x32x16_bf16 v[64:79], v[148:151], v[164:167], v[64:79]
    ds_read_b64_tr_b16 v[144:145], v18 offset:1024
    ds_read_b64_tr_b16 v[146:147], v18 offset:2560
    s_waitcnt vmcnt(0)
    s_barrier
    s_waitcnt lgkmcnt(4)
    v_mfma_f32_32x32x16_bf16 v[32:47], v[136:139], v[128:131], v[32:47]
    ds_read_b128 v[148:151], v16 offset:1024
    ds_read_b64_tr_b16 v[156:157], v18 offset:6144
    ds_read_b64_tr_b16 v[158:159], v18 offset:7680
    s_waitcnt lgkmcnt(5)
    v_mfma_f32_32x32x16_bf16 v[48:63], v[128:131], v[140:143], v[48:63]
    ds_read_b64_tr_b16 v[160:161], v18 offset:6656
    ds_read_b64_tr_b16 v[162:163], v18 offset:8192
    s_waitcnt lgkmcnt(5)
    v_mfma_f32_32x32x16_bf16 v[64:79], v[128:131], v[144:147], v[64:79]
    ds_read_b64_tr_b16 v[164:165], v18 offset:7168
    ds_read_b64_tr_b16 v[166:167], v18 offset:8704
    s_waitcnt lgkmcnt(4)
    v_mfma_f32_32x32x16_bf16 v[32:47], v[156:159], v[148:151], v[32:47]
    ds_read_b128 v[128:131], v16 offset:2048
    ds_read_b64_tr_b16 v[136:137], v18 offset:12288
    ds_read_b64_tr_b16 v[138:139], v18 offset:13824
    s_waitcnt lgkmcnt(5)
    v_mfma_f32_32x32x16_bf16 v[48:63], v[148:151], v[160:163], v[48:63]
    ds_read_b64_tr_b16 v[140:141], v18 offset:12800
    ds_read_b64_tr_b16 v[142:143], v18 offset:14336
    s_waitcnt lgkmcnt(5)
    v_mfma_f32_32x32x16_bf16 v[64:79], v[148:151], v[164:167], v[64:79]
    ds_read_b64_tr_b16 v[144:145], v18 offset:13312
    ds_read_b64_tr_b16 v[146:147], v18 offset:14848
    s_waitcnt lgkmcnt(4)
    v_mfma_f32_32x32x16_bf16 v[32:47], v[136:139], v[128:131], v[32:47]
    ds_read_b128 v[148:151], v16 offset:3072
    ds_read_b64_tr_b16 v[156:157], v18 offset:18432
    ds_read_b64_tr_b16 v[158:159], v18 offset:19968
    s_waitcnt lgkmcnt(5)
    v_mfma_f32_32x32x16_bf16 v[48:63], v[128:131], v[140:143], v[48:63]
    ds_read_b64_tr_b16 v[160:161], v18 offset:18944
    ds_read_b64_tr_b16 v[162:163], v18 offset:20480
    s_waitcnt lgkmcnt(5)
    v_mfma_f32_32x32x16_bf16 v[64:79], v[128:131], v[144:147], v[64:79]
    ds_read_b64_tr_b16 v[164:165], v18 offset:19456
    ds_read_b64_tr_b16 v[166:167], v18 offset:20992
    s_waitcnt lgkmcnt(4)
    v_mfma_f32_32x32x16_bf16 v[32:47], v[156:159], v[148:151], v[32:47]
    s_waitcnt lgkmcnt(2)
    v_mfma_f32_32x32x16_bf16 v[48:63], v[148:151], v[160:163], v[48:63]
    s_waitcnt lgkmcnt(0)
    v_mfma_f32_32x32x16_bf16 v[64:79], v[148:151], v[164:167], v[64:79]
    v_mov_b32 v20, 0x3fb8aa3b
    v_mov_b32 v21, 0x3fb8aa3b
    v_mov_b32 v22, 0x358637bd
    v_mov_b32 v23, 0x358637bd
    v_mov_b32 v24, 0xffff0000
    s_add_u32 s16, s6, 0x400000
    s_addc_u32 s17, s7, 0
    s_and_b32 s17, s17, 0xffff
    s_mov_b32 s18, 0x400000
    s_mov_b32 s19, 0x00020000
    s_add_u32 s60, s6, 0x800000
    s_addc_u32 s61, s7, 0
    s_and_b32 s61, s61, 0xffff
    s_mov_b32 s62, 0x200000
    s_mov_b32 s63, 0x00020000
    s_add_u32 s56, s6, 0xa00000
    s_addc_u32 s57, s7, 0
    s_and_b32 s57, s57, 0xffff
    s_mov_b32 s58, 0x10000
    s_mov_b32 s59, 0x00020000
    s_nop 7
    v_cvt_pk_bf16_f32 v152, v48, v49
    v_cvt_pk_bf16_f32 v153, v50, v51
    v_cvt_pk_bf16_f32 v154, v52, v53
    v_cvt_pk_bf16_f32 v155, v54, v55
    v_cvt_pk_bf16_f32 v156, v56, v57
    v_cvt_pk_bf16_f32 v157, v58, v59
    v_cvt_pk_bf16_f32 v158, v60, v61
    v_cvt_pk_bf16_f32 v159, v62, v63
    v_lshlrev_b32 v48, 16, v152
    v_and_b32 v49, v24, v152
    v_lshlrev_b32 v50, 16, v153
    v_and_b32 v51, v24, v153
    v_lshlrev_b32 v52, 16, v154
    v_and_b32 v53, v24, v154
    v_lshlrev_b32 v54, 16, v155
    v_and_b32 v55, v24, v155
    v_lshlrev_b32 v56, 16, v156
    v_and_b32 v57, v24, v156
    v_lshlrev_b32 v58, 16, v157
    v_and_b32 v59, v24, v157
    v_lshlrev_b32 v60, 16, v158
    v_and_b32 v61, v24, v158
    v_lshlrev_b32 v62, 16, v159
    v_and_b32 v63, v24, v159
    v_pk_mul_f32 v[152:153], v[48:49], v[20:21]
    v_pk_mul_f32 v[154:155], v[50:51], v[20:21]
    v_pk_mul_f32 v[156:157], v[52:53], v[20:21]
    v_pk_mul_f32 v[158:159], v[54:55], v[20:21]
    v_pk_mul_f32 v[160:161], v[56:57], v[20:21]
    v_pk_mul_f32 v[162:163], v[58:59], v[20:21]
    v_pk_mul_f32 v[164:165], v[60:61], v[20:21]
    v_pk_mul_f32 v[166:167], v[62:63], v[20:21]
    v_min_f32 v152, 0, v152
    v_min_f32 v153, 0, v153
    v_min_f32 v154, 0, v154
    v_min_f32 v155, 0, v155
    v_min_f32 v156, 0, v156
    v_min_f32 v157, 0, v157
    v_min_f32 v158, 0, v158
    v_min_f32 v159, 0, v159
    v_min_f32 v160, 0, v160
    v_min_f32 v161, 0, v161
    v_min_f32 v162, 0, v162
    v_min_f32 v163, 0, v163
    v_min_f32 v164, 0, v164
    v_min_f32 v165, 0, v165
    v_min_f32 v166, 0, v166
    v_min_f32 v167, 0, v167
    v_exp_f32 v152, v152
    v_exp_f32 v153, v153
    v_exp_f32 v154, v154
    v_exp_f32 v155, v155
    v_exp_f32 v156, v156
    v_exp_f32 v157, v157
    v_exp_f32 v158, v158
    v_exp_f32 v159, v159
    v_exp_f32 v160, v160
    v_exp_f32 v161, v161
    v_exp_f32 v162, v162
    v_exp_f32 v163, v163
    v_exp_f32 v164, v164
    v_exp_f32 v165, v165
    v_exp_f32 v166, v166
    v_exp_f32 v167, v167
    v_max_f32 v48, 0, v48
    v_max_f32 v49, 0, v49
    v_max_f32 v50, 0, v50
    v_max_f32 v51, 0, v51
    v_max_f32 v52, 0, v52
    v_max_f32 v53, 0, v53
    v_max_f32 v54, 0, v54
    v_max_f32 v55, 0, v55
    v_max_f32 v56, 0, v56
    v_max_f32 v57, 0, v57
    v_max_f32 v58, 0, v58
    v_max_f32 v59, 0, v59
    v_max_f32 v60, 0, v60
    v_max_f32 v61, 0, v61
    v_max_f32 v62, 0, v62
    v_max_f32 v63, 0, v63
    v_pk_add_f32 v[152:153], v[152:153], v[22:23]
    v_pk_add_f32 v[154:155], v[154:155], v[22:23]
    v_pk_add_f32 v[156:157], v[156:157], v[22:23]
    v_pk_add_f32 v[158:159], v[158:159], v[22:23]
    v_pk_add_f32 v[160:161], v[160:161], v[22:23]
    v_pk_add_f32 v[162:163], v[162:163], v[22:23]
    v_pk_add_f32 v[164:165], v[164:165], v[22:23]
    v_pk_add_f32 v[166:167], v[166:167], v[22:23]
    v_pk_add_f32 v[48:49], v[48:49], v[152:153]
    v_pk_add_f32 v[50:51], v[50:51], v[154:155]
    v_pk_add_f32 v[52:53], v[52:53], v[156:157]
    v_pk_add_f32 v[54:55], v[54:55], v[158:159]
    v_pk_add_f32 v[56:57], v[56:57], v[160:161]
    v_pk_add_f32 v[58:59], v[58:59], v[162:163]
    v_pk_add_f32 v[60:61], v[60:61], v[164:165]
    v_pk_add_f32 v[62:63], v[62:63], v[166:167]
    v_cvt_pk_bf16_f32 v136, v48, v49
    v_cvt_pk_bf16_f32 v137, v50, v51
    v_cvt_pk_bf16_f32 v138, v52, v53
    v_cvt_pk_bf16_f32 v139, v54, v55
    v_cvt_pk_bf16_f32 v140, v56, v57
    v_cvt_pk_bf16_f32 v141, v58, v59
    v_cvt_pk_bf16_f32 v142, v60, v61
    v_cvt_pk_bf16_f32 v143, v62, v63
    v_cvt_pk_bf16_f32 v144, v64, v65
    v_cvt_pk_bf16_f32 v145, v66, v67
    v_cvt_pk_bf16_f32 v146, v68, v69
    v_cvt_pk_bf16_f32 v147, v70, v71
    v_cvt_pk_bf16_f32 v148, v72, v73
    v_cvt_pk_bf16_f32 v149, v74, v75
    v_cvt_pk_bf16_f32 v150, v76, v77
    v_cvt_pk_bf16_f32 v151, v78, v79
    s_nop 1
    v_mfma_f32_32x32x16_bf16 v[96:111], v[136:139], v[144:147], 0
    v_mfma_f32_32x32x16_bf16 v[96:111], v[140:143], v[148:151], v[96:111]
    v_lshlrev_b32 v152, 16, v136
    v_and_b32 v153, v24, v136
    v_lshlrev_b32 v154, 16, v137
    v_and_b32 v155, v24, v137
    v_lshlrev_b32 v156, 16, v138
    v_and_b32 v157, v24, v138
    v_lshlrev_b32 v158, 16, v139
    v_and_b32 v159, v24, v139
    v_lshlrev_b32 v160, 16, v140
    v_and_b32 v161, v24, v140
    v_lshlrev_b32 v162, 16, v141
    v_and_b32 v163, v24, v141
    v_lshlrev_b32 v164, 16, v142
    v_and_b32 v165, v24, v142
    v_lshlrev_b32 v166, 16, v143
    v_and_b32 v167, v24, v143
    v_pk_add_f32 v[152:153], v[152:153], v[160:161]
    v_pk_add_f32 v[154:155], v[154:155], v[162:163]
    v_pk_add_f32 v[156:157], v[156:157], v[164:165]
    v_pk_add_f32 v[158:159], v[158:159], v[166:167]
    v_pk_add_f32 v[152:153], v[152:153], v[156:157]
    v_pk_add_f32 v[154:155], v[154:155], v[158:159]
    v_pk_add_f32 v[152:153], v[152:153], v[154:155]
    v_add_f32 v25, v152, v153
    v_cvt_pk_bf16_f32 v152, v32, v33
    v_cvt_pk_bf16_f32 v153, v34, v35
    v_cvt_pk_bf16_f32 v154, v36, v37
    v_cvt_pk_bf16_f32 v155, v38, v39
    v_cvt_pk_bf16_f32 v156, v40, v41
    v_cvt_pk_bf16_f32 v157, v42, v43
    v_cvt_pk_bf16_f32 v158, v44, v45
    v_cvt_pk_bf16_f32 v159, v46, v47
    v_lshlrev_b32 v32, 16, v152
    v_and_b32 v33, v24, v152
    v_lshlrev_b32 v34, 16, v153
    v_and_b32 v35, v24, v153
    v_lshlrev_b32 v36, 16, v154
    v_and_b32 v37, v24, v154
    v_lshlrev_b32 v38, 16, v155
    v_and_b32 v39, v24, v155
    v_lshlrev_b32 v40, 16, v156
    v_and_b32 v41, v24, v156
    v_lshlrev_b32 v42, 16, v157
    v_and_b32 v43, v24, v157
    v_lshlrev_b32 v44, 16, v158
    v_and_b32 v45, v24, v158
    v_lshlrev_b32 v46, 16, v159
    v_and_b32 v47, v24, v159
    v_pk_mul_f32 v[152:153], v[32:33], v[20:21]
    v_pk_mul_f32 v[154:155], v[34:35], v[20:21]
    v_pk_mul_f32 v[156:157], v[36:37], v[20:21]
    v_pk_mul_f32 v[158:159], v[38:39], v[20:21]
    v_pk_mul_f32 v[160:161], v[40:41], v[20:21]
    v_pk_mul_f32 v[162:163], v[42:43], v[20:21]
    v_pk_mul_f32 v[164:165], v[44:45], v[20:21]
    v_pk_mul_f32 v[166:167], v[46:47], v[20:21]
    v_min_f32 v152, 0, v152
    v_min_f32 v153, 0, v153
    v_min_f32 v154, 0, v154
    v_min_f32 v155, 0, v155
    v_min_f32 v156, 0, v156
    v_min_f32 v157, 0, v157
    v_min_f32 v158, 0, v158
    v_min_f32 v159, 0, v159
    v_min_f32 v160, 0, v160
    v_min_f32 v161, 0, v161
    v_min_f32 v162, 0, v162
    v_min_f32 v163, 0, v163
    v_min_f32 v164, 0, v164
    v_min_f32 v165, 0, v165
    v_min_f32 v166, 0, v166
    v_min_f32 v167, 0, v167
    v_exp_f32 v152, v152
    v_exp_f32 v153, v153
    v_exp_f32 v154, v154
    v_exp_f32 v155, v155
    v_exp_f32 v156, v156
    v_exp_f32 v157, v157
    v_exp_f32 v158, v158
    v_exp_f32 v159, v159
    v_exp_f32 v160, v160
    v_exp_f32 v161, v161
    v_exp_f32 v162, v162
    v_exp_f32 v163, v163
    v_exp_f32 v164, v164
    v_exp_f32 v165, v165
    v_exp_f32 v166, v166
    v_exp_f32 v167, v167
    v_max_f32 v32, 0, v32
    v_max_f32 v33, 0, v33
    v_max_f32 v34, 0, v34
    v_max_f32 v35, 0, v35
    v_max_f32 v36, 0, v36
    v_max_f32 v37, 0, v37
    v_max_f32 v38, 0, v38
    v_max_f32 v39, 0, v39
    v_max_f32 v40, 0, v40
    v_max_f32 v41, 0, v41
    v_max_f32 v42, 0, v42
    v_max_f32 v43, 0, v43
    v_max_f32 v44, 0, v44
    v_max_f32 v45, 0, v45
    v_max_f32 v46, 0, v46
    v_max_f32 v47, 0, v47
    v_pk_add_f32 v[152:153], v[152:153], v[22:23]
    v_pk_add_f32 v[154:155], v[154:155], v[22:23]
    v_pk_add_f32 v[156:157], v[156:157], v[22:23]
    v_pk_add_f32 v[158:159], v[158:159], v[22:23]
    v_pk_add_f32 v[160:161], v[160:161], v[22:23]
    v_pk_add_f32 v[162:163], v[162:163], v[22:23]
    v_pk_add_f32 v[164:165], v[164:165], v[22:23]
    v_pk_add_f32 v[166:167], v[166:167], v[22:23]
    v_pk_add_f32 v[32:33], v[32:33], v[152:153]
    v_pk_add_f32 v[34:35], v[34:35], v[154:155]
    v_pk_add_f32 v[36:37], v[36:37], v[156:157]
    v_pk_add_f32 v[38:39], v[38:39], v[158:159]
    v_pk_add_f32 v[40:41], v[40:41], v[160:161]
    v_pk_add_f32 v[42:43], v[42:43], v[162:163]
    v_pk_add_f32 v[44:45], v[44:45], v[164:165]
    v_pk_add_f32 v[46:47], v[46:47], v[166:167]
    v_cvt_pk_bf16_f32 v128, v32, v33
    v_cvt_pk_bf16_f32 v129, v34, v35
    v_cvt_pk_bf16_f32 v130, v36, v37
    v_cvt_pk_bf16_f32 v131, v38, v39
    v_cvt_pk_bf16_f32 v132, v40, v41
    v_cvt_pk_bf16_f32 v133, v42, v43
    v_cvt_pk_bf16_f32 v134, v44, v45
    v_cvt_pk_bf16_f32 v135, v46, v47
    s_lshl_b32 s30, s23, 2
    s_add_u32 s30, s30, s27
    s_lshl_b32 s30, s30, 6
    s_lshl_b32 s31, s22, 1
    s_add_u32 s31, s31, s28
    s_lshl_b32 s32, s31, 1
    s_add_u32 s30, s30, s32
    s_lshl_b32 s30, s30, 10
    v_add_u32 v3, s30, v9
    buffer_store_dwordx4 v[128:131], v3, s[16:19], 0 offen sc1
    buffer_store_dwordx4 v[132:135], v3, s[16:19], 0 offen offset:1024 sc1
    s_lshl_b32 s30, s25, 12
    s_add_u32 s30, s30, 98304
    v_add_u32 v4, s30, v9
    s_lshl_b32 s30, s25, 8
    s_add_u32 s30, s30, 131072
    v_lshlrev_b32 v5, 2, v2
    v_add_u32 v5, s30, v5
    s_barrier
    ds_write_b32 v5, v25
    ds_write_b128 v4, v[96:99] offset:0
    ds_write_b128 v4, v[100:103] offset:1024
    ds_write_b128 v4, v[104:107] offset:2048
    ds_write_b128 v4, v[108:111] offset:3072
    s_lshr_b32 s30, s25, 1
    s_lshl_b32 s31, s30, 10
    s_lshl_b32 s32, s28, 12
    s_add_u32 s31, s31, s32
    s_add_u32 s31, s31, 98304
    v_add_u32 v4, s31, v9
    s_lshl_b32 s32, s28, 8
    s_add_u32 s32, s32, 131072
    v_and_b32 v6, 31, v2
    v_lshlrev_b32 v6, 2, v6
    v_add_u32 v6, s32, v6
    s_waitcnt lgkmcnt(0)
    s_barrier
    ds_read_b128 v[32:35], v4 offset:0
    ds_read_b128 v[36:39], v4 offset:8192
    ds_read_b128 v[40:43], v4 offset:16384
    ds_read_b128 v[44:47], v4 offset:24576
    ds_read_b32 v48, v6 offset:0
    ds_read_b32 v49, v6 offset:128
    ds_read_b32 v50, v6 offset:512
    ds_read_b32 v51, v6 offset:640
    ds_read_b32 v52, v6 offset:1024
    ds_read_b32 v53, v6 offset:1152
    ds_read_b32 v54, v6 offset:1536
    ds_read_b32 v55, v6 offset:1664
    s_lshl_b32 s33, s23, 5
    s_lshl_b32 s34, s22, 1
    s_add_u32 s33, s33, s34
    s_add_u32 s33, s33, s28
    s_lshl_b32 s34, s33, 12
    s_lshl_b32 s35, s30, 10
    s_add_u32 s34, s34, s35
    v_add_u32 v4, s34, v9
    s_waitcnt lgkmcnt(8)
    v_pk_add_f32 v[32:33], v[32:33], v[36:37]
    v_pk_add_f32 v[40:41], v[40:41], v[44:45]
    v_pk_add_f32 v[32:33], v[32:33], v[40:41]
    v_pk_add_f32 v[34:35], v[34:35], v[38:39]
    v_pk_add_f32 v[42:43], v[42:43], v[46:47]
    v_pk_add_f32 v[34:35], v[34:35], v[42:43]
    buffer_store_dwordx4 v[32:35], v4, s[60:63], 0 offen sc1
    s_cmp_lg_u32 s30, 0
    s_cbranch_scc1 L_k1_qkv_kernel_fin_3
    s_waitcnt lgkmcnt(0)
    v_add_f32 v48, v48, v49
    v_add_f32 v48, v48, v50
    v_add_f32 v48, v48, v51
    v_add_f32 v48, v48, v52
    v_add_f32 v48, v48, v53
    v_add_f32 v48, v48, v54
    v_add_f32 v48, v48, v55
    v_cmp_gt_u32 vcc, 32, v2
    s_and_saveexec_b64 s[36:37], vcc
    s_lshl_b32 s34, s33, 7
    v_lshlrev_b32 v6, 2, v2
    v_add_u32 v6, s34, v6
    buffer_store_dword v48, v6, s[56:59], 0 offen sc1
L_k1_qkv_kernel_fin_3:
L_k1_qkv_kernel_end_1:
    s_endpgm
.globl k15_o_kernel
.p2align 8
.type k15_o_kernel,@function
k15_o_kernel:
    s_cmp_ge_u32 s2, 256
    s_cbranch_scc1 L_k15_o_kernel_end_1
    s_load_dwordx2 s[6:7], s[0:1], 72
    s_load_dwordx4 s[60:63], s[0:1], 32
    s_cmp_lt_u32 s2, 256
    s_cbranch_scc1 L_k15_o_kernel_o_2
    s_waitcnt lgkmcnt(0)
    s_sub_u32 s3, s2, 32
    s_cmp_ge_u32 s3, 112
    s_cselect_b32 s28, s62, s60
    s_cselect_b32 s29, s63, s61
    s_cselect_b32 s30, 112, 0
    s_cselect_b32 s38, 14336, 0
    s_sub_u32 s31, s3, s30
    s_mul_i32 s32, s31, 2341
    s_lshr_b32 s32, s32, 16
    s_mul_i32 s33, s32, 28
    s_sub_u32 s33, s31, s33
    s_mov_b32 s8, s28
    s_and_b32 s9, s29, 0xffff
    s_mov_b32 s10, 0x700000
    s_mov_b32 s11, 0x00020000
    s_add_u32 s12, s6, 0xb00000
    s_addc_u32 s13, s7, 0
    s_and_b32 s13, s13, 0xffff
    s_mov_b32 s14, 0x1c000
    s_mov_b32 s15, 0x00020000
    v_and_b32 v1, 15, v0
    v_lshrrev_b32 v2, 4, v0
    s_lshl_b32 s34, s33, 8
    s_mul_i32 s35, s32, 1835008
    s_add_u32 s34, s34, s35
    s_movk_i32 s35, 7168
    v_mul_lo_u32 v3, v2, s35
    v_lshl_add_u32 v3, v1, 4, v3
    v_add_u32 v3, s34, v3
    s_mov_b32 s34, 0
    buffer_load_dwordx4 v[16:19], v3, s[8:11], s34 offen
    s_add_u32 s34, s34, 114688
    buffer_load_dwordx4 v[20:23], v3, s[8:11], s34 offen
    s_add_u32 s34, s34, 114688
    buffer_load_dwordx4 v[24:27], v3, s[8:11], s34 offen
    s_add_u32 s34, s34, 114688
    buffer_load_dwordx4 v[28:31], v3, s[8:11], s34 offen
    s_add_u32 s34, s34, 114688
    buffer_load_dwordx4 v[32:35], v3, s[8:11], s34 offen
    s_add_u32 s34, s34, 114688
    buffer_load_dwordx4 v[36:39], v3, s[8:11], s34 offen
    s_add_u32 s34, s34, 114688
    buffer_load_dwordx4 v[40:43], v3, s[8:11], s34 offen
    s_add_u32 s34, s34, 114688
    buffer_load_dwordx4 v[44:47], v3, s[8:11], s34 offen
    s_add_u32 s34, s34, 114688
    buffer_load_dwordx4 v[48:51], v3, s[8:11], s34 offen
    s_add_u32 s34, s34, 114688
    buffer_load_dwordx4 v[52:55], v3, s[8:11], s34 offen
    s_add_u32 s34, s34, 114688
    buffer_load_dwordx4 v[56:59], v3, s[8:11], s34 offen
    s_add_u32 s34, s34, 114688
    buffer_load_dwordx4 v[60:63], v3, s[8:11], s34 offen
    s_add_u32 s34, s34, 114688
    buffer_load_dwordx4 v[64:67], v3, s[8:11], s34 offen
    s_add_u32 s34, s34, 114688
    buffer_load_dwordx4 v[68:71], v3, s[8:11], s34 offen
    s_add_u32 s34, s34, 114688
    buffer_load_dwordx4 v[72:75], v3, s[8:11], s34 offen
    s_add_u32 s34, s34, 114688
    buffer_load_dwordx4 v[76:79], v3, s[8:11], s34 offen
    v_mov_b32 v4, 0xffff0000
    v_mov_b32 v8, 0
    v_mov_b32 v9, 0
    v_mov_b32 v10, 0
    v_mov_b32 v11, 0
    v_mov_b32 v12, 0
    v_mov_b32 v13, 0
    v_mov_b32 v14, 0
    v_mov_b32 v15, 0
    s_waitcnt vmcnt(15)
    v_lshlrev_b32 v5, 16, v16
    v_and_b32 v6, v4, v16
    v_add_f32 v8, v8, v5
    v_add_f32 v9, v9, v6
    v_lshlrev_b32 v5, 16, v17
    v_and_b32 v6, v4, v17
    v_add_f32 v10, v10, v5
    v_add_f32 v11, v11, v6
    v_lshlrev_b32 v5, 16, v18
    v_and_b32 v6, v4, v18
    v_add_f32 v12, v12, v5
    v_add_f32 v13, v13, v6
    v_lshlrev_b32 v5, 16, v19
    v_and_b32 v6, v4, v19
    v_add_f32 v14, v14, v5
    v_add_f32 v15, v15, v6
    s_waitcnt vmcnt(14)
    v_lshlrev_b32 v5, 16, v20
    v_and_b32 v6, v4, v20
    v_add_f32 v8, v8, v5
    v_add_f32 v9, v9, v6
    v_lshlrev_b32 v5, 16, v21
    v_and_b32 v6, v4, v21
    v_add_f32 v10, v10, v5
    v_add_f32 v11, v11, v6
    v_lshlrev_b32 v5, 16, v22
    v_and_b32 v6, v4, v22
    v_add_f32 v12, v12, v5
    v_add_f32 v13, v13, v6
    v_lshlrev_b32 v5, 16, v23
    v_and_b32 v6, v4, v23
    v_add_f32 v14, v14, v5
    v_add_f32 v15, v15, v6
    s_waitcnt vmcnt(13)
    v_lshlrev_b32 v5, 16, v24
    v_and_b32 v6, v4, v24
    v_add_f32 v8, v8, v5
    v_add_f32 v9, v9, v6
    v_lshlrev_b32 v5, 16, v25
    v_and_b32 v6, v4, v25
    v_add_f32 v10, v10, v5
    v_add_f32 v11, v11, v6
    v_lshlrev_b32 v5, 16, v26
    v_and_b32 v6, v4, v26
    v_add_f32 v12, v12, v5
    v_add_f32 v13, v13, v6
    v_lshlrev_b32 v5, 16, v27
    v_and_b32 v6, v4, v27
    v_add_f32 v14, v14, v5
    v_add_f32 v15, v15, v6
    s_waitcnt vmcnt(12)
    v_lshlrev_b32 v5, 16, v28
    v_and_b32 v6, v4, v28
    v_add_f32 v8, v8, v5
    v_add_f32 v9, v9, v6
    v_lshlrev_b32 v5, 16, v29
    v_and_b32 v6, v4, v29
    v_add_f32 v10, v10, v5
    v_add_f32 v11, v11, v6
    v_lshlrev_b32 v5, 16, v30
    v_and_b32 v6, v4, v30
    v_add_f32 v12, v12, v5
    v_add_f32 v13, v13, v6
    v_lshlrev_b32 v5, 16, v31
    v_and_b32 v6, v4, v31
    v_add_f32 v14, v14, v5
    v_add_f32 v15, v15, v6
    s_waitcnt vmcnt(11)
    v_lshlrev_b32 v5, 16, v32
    v_and_b32 v6, v4, v32
    v_add_f32 v8, v8, v5
    v_add_f32 v9, v9, v6
    v_lshlrev_b32 v5, 16, v33
    v_and_b32 v6, v4, v33
    v_add_f32 v10, v10, v5
    v_add_f32 v11, v11, v6
    v_lshlrev_b32 v5, 16, v34
    v_and_b32 v6, v4, v34
    v_add_f32 v12, v12, v5
    v_add_f32 v13, v13, v6
    v_lshlrev_b32 v5, 16, v35
    v_and_b32 v6, v4, v35
    v_add_f32 v14, v14, v5
    v_add_f32 v15, v15, v6
    s_waitcnt vmcnt(10)
    v_lshlrev_b32 v5, 16, v36
    v_and_b32 v6, v4, v36
    v_add_f32 v8, v8, v5
    v_add_f32 v9, v9, v6
    v_lshlrev_b32 v5, 16, v37
    v_and_b32 v6, v4, v37
    v_add_f32 v10, v10, v5
    v_add_f32 v11, v11, v6
    v_lshlrev_b32 v5, 16, v38
    v_and_b32 v6, v4, v38
    v_add_f32 v12, v12, v5
    v_add_f32 v13, v13, v6
    v_lshlrev_b32 v5, 16, v39
    v_and_b32 v6, v4, v39
    v_add_f32 v14, v14, v5
    v_add_f32 v15, v15, v6
    s_waitcnt vmcnt(9)
    v_lshlrev_b32 v5, 16, v40
    v_and_b32 v6, v4, v40
    v_add_f32 v8, v8, v5
    v_add_f32 v9, v9, v6
    v_lshlrev_b32 v5, 16, v41
    v_and_b32 v6, v4, v41
    v_add_f32 v10, v10, v5
    v_add_f32 v11, v11, v6
    v_lshlrev_b32 v5, 16, v42
    v_and_b32 v6, v4, v42
    v_add_f32 v12, v12, v5
    v_add_f32 v13, v13, v6
    v_lshlrev_b32 v5, 16, v43
    v_and_b32 v6, v4, v43
    v_add_f32 v14, v14, v5
    v_add_f32 v15, v15, v6
    s_waitcnt vmcnt(8)
    v_lshlrev_b32 v5, 16, v44
    v_and_b32 v6, v4, v44
    v_add_f32 v8, v8, v5
    v_add_f32 v9, v9, v6
    v_lshlrev_b32 v5, 16, v45
    v_and_b32 v6, v4, v45
    v_add_f32 v10, v10, v5
    v_add_f32 v11, v11, v6
    v_lshlrev_b32 v5, 16, v46
    v_and_b32 v6, v4, v46
    v_add_f32 v12, v12, v5
    v_add_f32 v13, v13, v6
    v_lshlrev_b32 v5, 16, v47
    v_and_b32 v6, v4, v47
    v_add_f32 v14, v14, v5
    v_add_f32 v15, v15, v6
    s_waitcnt vmcnt(7)
    v_lshlrev_b32 v5, 16, v48
    v_and_b32 v6, v4, v48
    v_add_f32 v8, v8, v5
    v_add_f32 v9, v9, v6
    v_lshlrev_b32 v5, 16, v49
    v_and_b32 v6, v4, v49
    v_add_f32 v10, v10, v5
    v_add_f32 v11, v11, v6
    v_lshlrev_b32 v5, 16, v50
    v_and_b32 v6, v4, v50
    v_add_f32 v12, v12, v5
    v_add_f32 v13, v13, v6
    v_lshlrev_b32 v5, 16, v51
    v_and_b32 v6, v4, v51
    v_add_f32 v14, v14, v5
    v_add_f32 v15, v15, v6
    s_waitcnt vmcnt(6)
    v_lshlrev_b32 v5, 16, v52
    v_and_b32 v6, v4, v52
    v_add_f32 v8, v8, v5
    v_add_f32 v9, v9, v6
    v_lshlrev_b32 v5, 16, v53
    v_and_b32 v6, v4, v53
    v_add_f32 v10, v10, v5
    v_add_f32 v11, v11, v6
    v_lshlrev_b32 v5, 16, v54
    v_and_b32 v6, v4, v54
    v_add_f32 v12, v12, v5
    v_add_f32 v13, v13, v6
    v_lshlrev_b32 v5, 16, v55
    v_and_b32 v6, v4, v55
    v_add_f32 v14, v14, v5
    v_add_f32 v15, v15, v6
    s_waitcnt vmcnt(5)
    v_lshlrev_b32 v5, 16, v56
    v_and_b32 v6, v4, v56
    v_add_f32 v8, v8, v5
    v_add_f32 v9, v9, v6
    v_lshlrev_b32 v5, 16, v57
    v_and_b32 v6, v4, v57
    v_add_f32 v10, v10, v5
    v_add_f32 v11, v11, v6
    v_lshlrev_b32 v5, 16, v58
    v_and_b32 v6, v4, v58
    v_add_f32 v12, v12, v5
    v_add_f32 v13, v13, v6
    v_lshlrev_b32 v5, 16, v59
    v_and_b32 v6, v4, v59
    v_add_f32 v14, v14, v5
    v_add_f32 v15, v15, v6
    s_waitcnt vmcnt(4)
    v_lshlrev_b32 v5, 16, v60
    v_and_b32 v6, v4, v60
    v_add_f32 v8, v8, v5
    v_add_f32 v9, v9, v6
    v_lshlrev_b32 v5, 16, v61
    v_and_b32 v6, v4, v61
    v_add_f32 v10, v10, v5
    v_add_f32 v11, v11, v6
    v_lshlrev_b32 v5, 16, v62
    v_and_b32 v6, v4, v62
    v_add_f32 v12, v12, v5
    v_add_f32 v13, v13, v6
    v_lshlrev_b32 v5, 16, v63
    v_and_b32 v6, v4, v63
    v_add_f32 v14, v14, v5
    v_add_f32 v15, v15, v6
    s_waitcnt vmcnt(3)
    v_lshlrev_b32 v5, 16, v64
    v_and_b32 v6, v4, v64
    v_add_f32 v8, v8, v5
    v_add_f32 v9, v9, v6
    v_lshlrev_b32 v5, 16, v65
    v_and_b32 v6, v4, v65
    v_add_f32 v10, v10, v5
    v_add_f32 v11, v11, v6
    v_lshlrev_b32 v5, 16, v66
    v_and_b32 v6, v4, v66
    v_add_f32 v12, v12, v5
    v_add_f32 v13, v13, v6
    v_lshlrev_b32 v5, 16, v67
    v_and_b32 v6, v4, v67
    v_add_f32 v14, v14, v5
    v_add_f32 v15, v15, v6
    s_waitcnt vmcnt(2)
    v_lshlrev_b32 v5, 16, v68
    v_and_b32 v6, v4, v68
    v_add_f32 v8, v8, v5
    v_add_f32 v9, v9, v6
    v_lshlrev_b32 v5, 16, v69
    v_and_b32 v6, v4, v69
    v_add_f32 v10, v10, v5
    v_add_f32 v11, v11, v6
    v_lshlrev_b32 v5, 16, v70
    v_and_b32 v6, v4, v70
    v_add_f32 v12, v12, v5
    v_add_f32 v13, v13, v6
    v_lshlrev_b32 v5, 16, v71
    v_and_b32 v6, v4, v71
    v_add_f32 v14, v14, v5
    v_add_f32 v15, v15, v6
    s_waitcnt vmcnt(1)
    v_lshlrev_b32 v5, 16, v72
    v_and_b32 v6, v4, v72
    v_add_f32 v8, v8, v5
    v_add_f32 v9, v9, v6
    v_lshlrev_b32 v5, 16, v73
    v_and_b32 v6, v4, v73
    v_add_f32 v10, v10, v5
    v_add_f32 v11, v11, v6
    v_lshlrev_b32 v5, 16, v74
    v_and_b32 v6, v4, v74
    v_add_f32 v12, v12, v5
    v_add_f32 v13, v13, v6
    v_lshlrev_b32 v5, 16, v75
    v_and_b32 v6, v4, v75
    v_add_f32 v14, v14, v5
    v_add_f32 v15, v15, v6
    s_waitcnt vmcnt(0)
    v_lshlrev_b32 v5, 16, v76
    v_and_b32 v6, v4, v76
    v_add_f32 v8, v8, v5
    v_add_f32 v9, v9, v6
    v_lshlrev_b32 v5, 16, v77
    v_and_b32 v6, v4, v77
    v_add_f32 v10, v10, v5
    v_add_f32 v11, v11, v6
    v_lshlrev_b32 v5, 16, v78
    v_and_b32 v6, v4, v78
    v_add_f32 v12, v12, v5
    v_add_f32 v13, v13, v6
    v_lshlrev_b32 v5, 16, v79
    v_and_b32 v6, v4, v79
    v_add_f32 v14, v14, v5
    v_add_f32 v15, v15, v6
    v_lshlrev_b32 v5, 5, v0
    ds_write_b128 v5, v[8:11]
    ds_write_b128 v5, v[12:15] offset:16
    s_waitcnt lgkmcnt(0)
    s_barrier
    v_cmp_gt_u32 vcc, 128, v0
    s_and_saveexec_b64 s[36:37], vcc
    s_cbranch_execz L_k15_o_kernel_end_1
    v_lshlrev_b32 v5, 2, v0
    ds_read_b32 v16, v5 offset:0
    ds_read_b32 v17, v5 offset:512
    ds_read_b32 v18, v5 offset:1024
    ds_read_b32 v19, v5 offset:1536
    ds_read_b32 v20, v5 offset:2048
    ds_read_b32 v21, v5 offset:2560
    ds_read_b32 v22, v5 offset:3072
    ds_read_b32 v23, v5 offset:3584
    ds_read_b32 v24, v5 offset:4096
    ds_read_b32 v25, v5 offset:4608
    ds_read_b32 v26, v5 offset:5120
    ds_read_b32 v27, v5 offset:5632
    ds_read_b32 v28, v5 offset:6144
    ds_read_b32 v29, v5 offset:6656
    ds_read_b32 v30, v5 offset:7168
    ds_read_b32 v31, v5 offset:7680
    s_waitcnt lgkmcnt(0)
    v_add_f32 v16, v16, v17
    v_add_f32 v16, v16, v18
    v_add_f32 v16, v16, v19
    v_add_f32 v16, v16, v20
    v_add_f32 v16, v16, v21
    v_add_f32 v16, v16, v22
    v_add_f32 v16, v16, v23
    v_add_f32 v16, v16, v24
    v_add_f32 v16, v16, v25
    v_add_f32 v16, v16, v26
    v_add_f32 v16, v16, v27
    v_add_f32 v16, v16, v28
    v_add_f32 v16, v16, v29
    v_add_f32 v16, v16, v30
    v_add_f32 v16, v16, v31
    s_mul_i32 s35, s32, 28672
    s_add_u32 s35, s35, s38
    s_lshl_b32 s36, s33, 9
    s_add_u32 s35, s35, s36
    v_add_u32 v5, s35, v5
    buffer_store_dword v16, v5, s[12:15], 0 offen
    s_branch L_k15_o_kernel_end_1
L_k15_o_kernel_o_2:
    s_and_b32 s20, s2, 31
    s_lshr_b32 s21, s2, 5
    v_lshrrev_b32 v1, 6, v0
    v_and_b32 v2, 63, v0
    s_nop 0
    v_readfirstlane_b32 s25, v1
    s_waitcnt lgkmcnt(0)
    s_add_u32 s8, s6, 0x400000
    s_addc_u32 s9, s7, 0
    s_and_b32 s9, s9, 0xffff
    s_mov_b32 s10, 0x400000
    s_mov_b32 s11, 0x00020000
    s_add_u32 s12, s6, 0x800000
    s_addc_u32 s13, s7, 0
    s_and_b32 s13, s13, 0xffff
    s_mov_b32 s14, 0x200000
    s_mov_b32 s15, 0x00020000
    s_add_u32 s16, s6, 0xa00000
    s_addc_u32 s17, s7, 0
    s_and_b32 s17, s17, 0xffff
    s_mov_b32 s18, 0x10000
    s_mov_b32 s19, 0x00020000
    s_add_u32 s28, s6, 0x1000000
    s_addc_u32 s29, s7, 0
    s_and_b32 s29, s29, 0xffff
    s_mov_b32 s30, 0x400000
    s_mov_b32 s31, 0x00020000
    v_lshlrev_b32 v6, 4, v2
    s_lshl_b32 s23, s20, 12
    s_lshl_b32 s24, s25, 10
    s_add_u32 s23, s23, s24
    v_add_u32 v7, s23, v6
    s_mov_b32 s24, 0
    buffer_load_dwordx4 v[64:67], v7, s[12:15], s24 offen
    s_add_u32 s24, s24, 131072
    buffer_load_dwordx4 v[68:71], v7, s[12:15], s24 offen
    s_add_u32 s24, s24, 131072
    buffer_load_dwordx4 v[72:75], v7, s[12:15], s24 offen
    s_add_u32 s24, s24, 131072
    buffer_load_dwordx4 v[76:79], v7, s[12:15], s24 offen
    s_add_u32 s24, s24, 131072
    buffer_load_dwordx4 v[80:83], v7, s[12:15], s24 offen
    s_add_u32 s24, s24, 131072
    buffer_load_dwordx4 v[84:87], v7, s[12:15], s24 offen
    s_add_u32 s24, s24, 131072
    buffer_load_dwordx4 v[88:91], v7, s[12:15], s24 offen
    s_add_u32 s24, s24, 131072
    buffer_load_dwordx4 v[92:95], v7, s[12:15], s24 offen
    s_add_u32 s24, s24, 131072
    buffer_load_dwordx4 v[96:99], v7, s[12:15], s24 offen
    s_add_u32 s24, s24, 131072
    buffer_load_dwordx4 v[100:103], v7, s[12:15], s24 offen
    s_add_u32 s24, s24, 131072
    buffer_load_dwordx4 v[104:107], v7, s[12:15], s24 offen
    s_add_u32 s24, s24, 131072
    buffer_load_dwordx4 v[108:111], v7, s[12:15], s24 offen
    s_add_u32 s24, s24, 131072
    buffer_load_dwordx4 v[112:115], v7, s[12:15], s24 offen
    s_add_u32 s24, s24, 131072
    buffer_load_dwordx4 v[116:119], v7, s[12:15], s24 offen
    s_add_u32 s24, s24, 131072
    buffer_load_dwordx4 v[120:123], v7, s[12:15], s24 offen
    s_add_u32 s24, s24, 131072
    buffer_load_dwordx4 v[124:127], v7, s[12:15], s24 offen
    s_lshl_b32 s23, s20, 7
    v_and_b32 v8, 31, v2
    v_lshlrev_b32 v8, 2, v8
    v_add_u32 v8, s23, v8
    v_lshrrev_b32 v9, 5, v2
    v_lshl_add_u32 v8, v9, 15, v8
    s_mov_b32 s24, 0
    buffer_load_dword v128, v8, s[16:19], s24 offen
    s_add_u32 s24, s24, 4096
    buffer_load_dword v129, v8, s[16:19], s24 offen
    s_add_u32 s24, s24, 4096
    buffer_load_dword v130, v8, s[16:19], s24 offen
    s_add_u32 s24, s24, 4096
    buffer_load_dword v131, v8, s[16:19], s24 offen
    s_add_u32 s24, s24, 4096
    buffer_load_dword v132, v8, s[16:19], s24 offen
    s_add_u32 s24, s24, 4096
    buffer_load_dword v133, v8, s[16:19], s24 offen
    s_add_u32 s24, s24, 4096
    buffer_load_dword v134, v8, s[16:19], s24 offen
    s_add_u32 s24, s24, 4096
    buffer_load_dword v135, v8, s[16:19], s24 offen
    s_lshl_b32 s22, s21, 3
    s_lshl_b32 s23, s25, 1
    s_add_u32 s22, s22, s23
    s_lshl_b32 s22, s22, 6
    s_lshl_b32 s23, s20, 1
    s_add_u32 s22, s22, s23
    s_lshl_b32 s22, s22, 10
    v_add_u32 v3, s22, v6
    v_add_u32 v5, 0x10000, v3
    buffer_load_dwordx4 v[16:19], v3, s[8:11], 0 offen offset:0
    buffer_load_dwordx4 v[20:23], v3, s[8:11], 0 offen offset:1024
    buffer_load_dwordx4 v[24:27], v5, s[8:11], 0 offen offset:0
    buffer_load_dwordx4 v[28:31], v5, s[8:11], 0 offen offset:1024
    s_waitcnt vmcnt(12)
    v_pk_add_f32 v[64:65], v[64:65], v[96:97]
    v_pk_add_f32 v[66:67], v[66:67], v[98:99]
    v_pk_add_f32 v[68:69], v[68:69], v[100:101]
    v_pk_add_f32 v[70:71], v[70:71], v[102:103]
    v_pk_add_f32 v[72:73], v[72:73], v[104:105]
    v_pk_add_f32 v[74:75], v[74:75], v[106:107]
    v_pk_add_f32 v[76:77], v[76:77], v[108:109]
    v_pk_add_f32 v[78:79], v[78:79], v[110:111]
    v_pk_add_f32 v[80:81], v[80:81], v[112:113]
    v_pk_add_f32 v[82:83], v[82:83], v[114:115]
    v_pk_add_f32 v[84:85], v[84:85], v[116:117]
    v_pk_add_f32 v[86:87], v[86:87], v[118:119]
    v_pk_add_f32 v[88:89], v[88:89], v[120:121]
    v_pk_add_f32 v[90:91], v[90:91], v[122:123]
    v_pk_add_f32 v[92:93], v[92:93], v[124:125]
    v_pk_add_f32 v[94:95], v[94:95], v[126:127]
    v_pk_add_f32 v[64:65], v[64:65], v[80:81]
    v_pk_add_f32 v[66:67], v[66:67], v[82:83]
    v_pk_add_f32 v[68:69], v[68:69], v[84:85]
    v_pk_add_f32 v[70:71], v[70:71], v[86:87]
    v_pk_add_f32 v[72:73], v[72:73], v[88:89]
    v_pk_add_f32 v[74:75], v[74:75], v[90:91]
    v_pk_add_f32 v[76:77], v[76:77], v[92:93]
    v_pk_add_f32 v[78:79], v[78:79], v[94:95]
    v_pk_add_f32 v[64:65], v[64:65], v[72:73]
    v_pk_add_f32 v[66:67], v[66:67], v[74:75]
    v_pk_add_f32 v[68:69], v[68:69], v[76:77]
    v_pk_add_f32 v[70:71], v[70:71], v[78:79]
    v_pk_add_f32 v[64:65], v[64:65], v[68:69]
    v_pk_add_f32 v[66:67], v[66:67], v[70:71]
    s_lshl_b32 s23, s25, 10
    v_add_u32 v7, s23, v6
    ds_write_b128 v7, v[64:67]
    s_waitcnt vmcnt(4)
    v_pk_add_f32 v[128:129], v[128:129], v[132:133]
    v_pk_add_f32 v[130:131], v[130:131], v[134:135]
    v_pk_add_f32 v[128:129], v[128:129], v[130:131]
    v_add_f32 v128, v128, v129
    v_mov_b32 v129, v128
    s_nop 1
    v_permlane32_swap_b32 v128, v129
    s_nop 1
    v_add_f32 v128, v128, v129
    v_and_b32 v8, 31, v2
    v_lshlrev_b32 v8, 2, v8
    ds_write_b32 v8, v128 offset:4096
    s_waitcnt lgkmcnt(0)
    s_barrier
    ds_read_b128 v[64:67], v6 offset:0
    ds_read_b128 v[68:71], v6 offset:1024
    ds_read_b128 v[72:75], v6 offset:2048
    ds_read_b128 v[76:79], v6 offset:3072
    v_lshlrev_b32 v9, 4, v9
    ds_read_b128 v[80:83], v9 offset:4096
    ds_read_b128 v[84:87], v9 offset:4128
    ds_read_b128 v[88:91], v9 offset:4160
    ds_read_b128 v[92:95], v9 offset:4192
    v_and_b32 v10, 27, v2
    v_cmp_eq_u32 vcc, 0, v10
    s_waitcnt lgkmcnt(4)
    v_cvt_pk_bf16_f32 v96, v64, v65
    v_cvt_pk_bf16_f32 v97, v66, v67
    v_cvt_pk_bf16_f32 v98, v68, v69
    v_cvt_pk_bf16_f32 v99, v70, v71
    v_cvt_pk_bf16_f32 v100, v72, v73
    v_cvt_pk_bf16_f32 v101, v74, v75
    v_cvt_pk_bf16_f32 v102, v76, v77
    v_cvt_pk_bf16_f32 v103, v78, v79
    s_waitcnt lgkmcnt(0)
    v_cvt_pk_bf16_f32 v104, v80, v81
    v_cvt_pk_bf16_f32 v105, v82, v83
    v_cvt_pk_bf16_f32 v106, v84, v85
    v_cvt_pk_bf16_f32 v107, v86, v87
    v_cvt_pk_bf16_f32 v108, v88, v89
    v_cvt_pk_bf16_f32 v109, v90, v91
    v_cvt_pk_bf16_f32 v110, v92, v93
    v_cvt_pk_bf16_f32 v111, v94, v95
    v_cndmask_b32 v104, 0, v104, vcc
    v_cndmask_b32 v105, 0, v105, vcc
    v_cndmask_b32 v106, 0, v106, vcc
    v_cndmask_b32 v107, 0, v107, vcc
    v_cndmask_b32 v108, 0, v108, vcc
    v_cndmask_b32 v109, 0, v109, vcc
    v_cndmask_b32 v110, 0, v110, vcc
    v_cndmask_b32 v111, 0, v111, vcc
    s_waitcnt vmcnt(0)
    s_nop 0
    v_mfma_f32_32x32x16_bf16 v[128:143], v[104:107], v[16:19], 0
    v_mfma_f32_32x32x16_bf16 v[128:143], v[108:111], v[20:23], v[128:143]
    v_mfma_f32_32x32x16_bf16 v[112:127], v[96:99], v[16:19], 0
    v_mfma_f32_32x32x16_bf16 v[112:127], v[100:103], v[20:23], v[112:127]
    v_mfma_f32_32x32x16_bf16 v[160:175], v[104:107], v[24:27], 0
    v_mfma_f32_32x32x16_bf16 v[160:175], v[108:111], v[28:31], v[160:175]
    v_mfma_f32_32x32x16_bf16 v[144:159], v[96:99], v[24:27], 0
    v_mfma_f32_32x32x16_bf16 v[144:159], v[100:103], v[28:31], v[144:159]
    s_nop 7
    v_cvt_pk_bf16_f32 v12, v128, v128
    v_lshlrev_b32 v12, 16, v12
    v_add_f32 v12, 0x358637bd, v12
    v_cvt_pk_bf16_f32 v12, v12, v12
    v_lshlrev_b32 v12, 16, v12
    v_rcp_f32 v12, v12
    s_nop 0
    v_mov_b32 v13, v12
    v_cvt_pk_bf16_f32 v14, v160, v160
    v_lshlrev_b32 v14, 16, v14
    v_add_f32 v14, 0x358637bd, v14
    v_cvt_pk_bf16_f32 v14, v14, v14
    v_lshlrev_b32 v14, 16, v14
    v_rcp_f32 v14, v14
    s_nop 0
    v_mov_b32 v15, v14
    s_nop 7
    v_pk_mul_f32 v[112:113], v[112:113], v[12:13]
    v_pk_mul_f32 v[114:115], v[114:115], v[12:13]
    v_pk_mul_f32 v[116:117], v[116:117], v[12:13]
    v_pk_mul_f32 v[118:119], v[118:119], v[12:13]
    v_pk_mul_f32 v[120:121], v[120:121], v[12:13]
    v_pk_mul_f32 v[122:123], v[122:123], v[12:13]
    v_pk_mul_f32 v[124:125], v[124:125], v[12:13]
    v_pk_mul_f32 v[126:127], v[126:127], v[12:13]
    v_cvt_pk_bf16_f32 v32, v112, v113
    v_cvt_pk_bf16_f32 v33, v114, v115
    v_cvt_pk_bf16_f32 v34, v116, v117
    v_cvt_pk_bf16_f32 v35, v118, v119
    v_cvt_pk_bf16_f32 v36, v120, v121
    v_cvt_pk_bf16_f32 v37, v122, v123
    v_cvt_pk_bf16_f32 v38, v124, v125
    v_cvt_pk_bf16_f32 v39, v126, v127
    buffer_store_dwordx4 v[32:35], v3, s[28:31], 0 offen sc1
    buffer_store_dwordx4 v[36:39], v3, s[28:31], 0 offen offset:1024 sc1
    v_pk_mul_f32 v[144:145], v[144:145], v[14:15]
    v_pk_mul_f32 v[146:147], v[146:147], v[14:15]
    v_pk_mul_f32 v[148:149], v[148:149], v[14:15]
    v_pk_mul_f32 v[150:151], v[150:151], v[14:15]
    v_pk_mul_f32 v[152:153], v[152:153], v[14:15]
    v_pk_mul_f32 v[154:155], v[154:155], v[14:15]
    v_pk_mul_f32 v[156:157], v[156:157], v[14:15]
    v_pk_mul_f32 v[158:159], v[158:159], v[14:15]
    v_cvt_pk_bf16_f32 v40, v144, v145
    v_cvt_pk_bf16_f32 v41, v146, v147
    v_cvt_pk_bf16_f32 v42, v148, v149
    v_cvt_pk_bf16_f32 v43, v150, v151
    v_cvt_pk_bf16_f32 v44, v152, v153
    v_cvt_pk_bf16_f32 v45, v154, v155
    v_cvt_pk_bf16_f32 v46, v156, v157
    v_cvt_pk_bf16_f32 v47, v158, v159
    buffer_store_dwordx4 v[40:43], v5, s[28:31], 0 offen sc1
    buffer_store_dwordx4 v[44:47], v5, s[28:31], 0 offen offset:1024 sc1
L_k15_o_kernel_end_1:
    s_endpgm
.globl k2_wo_kernel
.p2align 8
.type k2_wo_kernel,@function
k2_wo_kernel:
    s_cmp_ge_u32 s2, 256
    s_cbranch_scc1 L_k2_wo_kernel_end_1
    s_load_dwordx2 s[4:5], s[0:1], 16
    s_load_dwordx2 s[6:7], s[0:1], 72
    s_load_dwordx2 s[60:61], s[0:1], 0
    s_and_b32 s20, s2, 7
    s_lshr_b32 s21, s2, 3
    s_and_b32 s22, s20, 1
    s_lshl_b32 s22, s22, 2
    s_and_b32 s23, s21, 3
    s_add_u32 s22, s22, s23
    s_lshr_b32 s23, s20, 1
    s_lshl_b32 s23, s23, 3
    s_lshr_b32 s24, s21, 2
    s_add_u32 s23, s23, s24
    s_lshl_b32 s24, s23, 6
    v_lshrrev_b32 v1, 6, v0
    v_and_b32 v2, 63, v0
    s_nop 0
    v_readfirstlane_b32 s25, v1
    s_lshr_b32 s26, s25, 1
    s_and_b32 s28, s25, 1
    s_lshr_b32 s27, s26, 1
    v_lshlrev_b32 v9, 4, v2
    s_lshl_b32 s30, s23, 1
    s_lshr_b32 s31, s25, 2
    s_add_u32 s30, s30, s31
    s_mul_i32 s30, s30, 64
    s_and_b32 s31, s25, 3
    s_add_u32 s30, s30, s31
    s_lshl_b32 s30, s30, 10
    v_add_u32 v10, s30, v9
    s_lshl_b32 s40, s25, 10
    s_lshl_b32 s30, s25, 3
    s_add_u32 s30, s30, 0
    v_bfe_u32 v6, v2, 2, 2
    v_add_u32 v6, s30, v6
    v_lshlrev_b32 v6, 11, v6
    v_lshrrev_b32 v7, 4, v2
    v_lshl_add_u32 v6, v7, 6, v6
    v_and_b32 v7, 3, v2
    v_lshl_add_u32 v6, v7, 4, v6
    s_lshl_b32 s31, s22, 8
    v_add_u32 v12, s31, v6
    s_lshl_b32 s42, s25, 11
    s_add_u32 s42, s42, 8192
    s_lshl_b32 s30, s25, 3
    s_add_u32 s30, s30, 4
    v_bfe_u32 v6, v2, 2, 2
    v_add_u32 v6, s30, v6
    v_lshlrev_b32 v6, 11, v6
    v_lshrrev_b32 v7, 4, v2
    v_lshl_add_u32 v6, v7, 6, v6
    v_and_b32 v7, 3, v2
    v_lshl_add_u32 v6, v7, 4, v6
    s_lshl_b32 s31, s22, 8
    v_add_u32 v13, s31, v6
    s_lshl_b32 s43, s25, 11
    s_add_u32 s43, s43, 9216
    s_mov_b32 s50, 0
    s_mov_b32 s51, 0
    s_waitcnt lgkmcnt(0)
    s_add_u32 s8, s6, 0x1000000
    s_addc_u32 s9, s7, 0
    s_and_b32 s9, s9, 0xffff
    s_mov_b32 s10, 0x400000
    s_mov_b32 s11, 0x00020000
    s_mov_b32 s12, s4
    s_and_b32 s13, s5, 0xffff
    s_mov_b32 s14, 0x200000
    s_mov_b32 s15, 0x00020000
    s_mov_b32 s52, 0
    s_mov_b32 s53, 0
    s_add_u32 m0, s52, s40
    s_nop 0
    buffer_load_dwordx4 v10, s[8:11], s50 offen lds
    s_add_u32 m0, s52, s42
    s_nop 0
    buffer_load_dwordx4 v12, s[12:15], s51 offen lds
    s_add_u32 m0, s52, s43
    s_nop 0
    buffer_load_dwordx4 v13, s[12:15], s51 offen lds
    s_add_u32 s50, s50, 0x1000
    s_add_u32 s51, s51, 0x20000
    s_add_u32 s52, s52, 24576
    s_cmp_ge_u32 s52, 147456
    s_cselect_b32 s52, 0, s52
    s_add_u32 m0, s52, s40
    s_nop 0
    buffer_load_dwordx4 v10, s[8:11], s50 offen lds
    s_add_u32 m0, s52, s42
    s_nop 0
    buffer_load_dwordx4 v12, s[12:15], s51 offen lds
    s_add_u32 m0, s52, s43
    s_nop 0
    buffer_load_dwordx4 v13, s[12:15], s51 offen lds
    s_add_u32 s50, s50, 0x1000
    s_add_u32 s51, s51, 0x20000
    s_add_u32 s52, s52, 24576
    s_cmp_ge_u32 s52, 147456
    s_cselect_b32 s52, 0, s52
    s_add_u32 m0, s52, s40
    s_nop 0
    buffer_load_dwordx4 v10, s[8:11], s50 offen lds
    s_add_u32 m0, s52, s42
    s_nop 0
    buffer_load_dwordx4 v12, s[12:15], s51 offen lds
    s_add_u32 m0, s52, s43
    s_nop 0
    buffer_load_dwordx4 v13, s[12:15], s51 offen lds
    s_add_u32 s50, s50, 0x1000
    s_add_u32 s51, s51, 0x20000
    s_add_u32 s52, s52, 24576
    s_cmp_ge_u32 s52, 147456
    s_cselect_b32 s52, 0, s52
    s_add_u32 m0, s52, s40
    s_nop 0
    buffer_load_dwordx4 v10, s[8:11], s50 offen lds
    s_add_u32 m0, s52, s42
    s_nop 0
    buffer_load_dwordx4 v12, s[12:15], s51 offen lds
    s_add_u32 m0, s52, s43
    s_nop 0
    buffer_load_dwordx4 v13, s[12:15], s51 offen lds
    s_add_u32 s50, s50, 0x1000
    s_add_u32 s51, s51, 0x20000
    s_add_u32 s52, s52, 24576
    s_cmp_ge_u32 s52, 147456
    s_cselect_b32 s52, 0, s52
    s_add_u32 m0, s52, s40
    s_nop 0
    buffer_load_dwordx4 v10, s[8:11], s50 offen lds
    s_add_u32 m0, s52, s42
    s_nop 0
    buffer_load_dwordx4 v12, s[12:15], s51 offen lds
    s_add_u32 m0, s52, s43
    s_nop 0
    buffer_load_dwordx4 v13, s[12:15], s51 offen lds
    s_add_u32 s50, s50, 0x1000
    s_add_u32 s51, s51, 0x20000
    s_add_u32 s52, s52, 24576
    s_cmp_ge_u32 s52, 147456
    s_cselect_b32 s52, 0, s52
    s_xor_b32 s30, s27, 0
    s_lshl_b32 s30, s30, 2
    s_add_u32 s30, s30, s26
    s_lshl_b32 s30, s30, 10
    v_add_u32 v16, s30, v9
    s_xor_b32 s30, s27, 1
    s_lshl_b32 s30, s30, 2
    s_add_u32 s30, s30, s26
    s_lshl_b32 s30, s30, 10
    v_add_u32 v17, s30, v9
    v_bfe_u32 v3, v2, 2, 2
    v_lshlrev_b32 v3, 6, v3
    v_bfe_u32 v4, v2, 4, 1
    v_lshl_add_u32 v3, v4, 5, v3
    v_and_b32 v4, 3, v2
    v_lshl_add_u32 v3, v4, 3, v3
    v_lshrrev_b32 v4, 5, v2
    v_mul_u32_u24 v4, 1024, v4
    v_add_u32 v3, v3, v4
    s_and_b32 s30, s26, 1
    s_xor_b32 s30, s30, 0
    s_lshl_b32 s31, s28, 1
    s_add_u32 s30, s30, s31
    s_lshl_b32 s30, s30, 8
    s_lshl_b32 s31, s26, 12
    s_add_u32 s30, s30, s31
    s_add_u32 s30, s30, 8192
    v_add_u32 v18, s30, v3
    s_and_b32 s30, s26, 1
    s_xor_b32 s30, s30, 1
    s_lshl_b32 s31, s28, 1
    s_add_u32 s30, s30, s31
    s_lshl_b32 s30, s30, 8
    s_lshl_b32 s31, s26, 12
    s_add_u32 s30, s30, s31
    s_add_u32 s30, s30, 8192
    v_add_u32 v19, s30, v3
    v_mov_b32 v64, 0
    v_mov_b32 v65, 0
    v_mov_b32 v66, 0
    v_mov_b32 v67, 0
    v_mov_b32 v68, 0
    v_mov_b32 v69, 0
    v_mov_b32 v70, 0
    v_mov_b32 v71, 0
    v_mov_b32 v72, 0
    v_mov_b32 v73, 0
    v_mov_b32 v74, 0
    v_mov_b32 v75, 0
    v_mov_b32 v76, 0
    v_mov_b32 v77, 0
    v_mov_b32 v78, 0
    v_mov_b32 v79, 0
    v_mov_b32 v80, 0
    v_mov_b32 v81, 0
    v_mov_b32 v82, 0
    v_mov_b32 v83, 0
    v_mov_b32 v84, 0
    v_mov_b32 v85, 0
    v_mov_b32 v86, 0
    v_mov_b32 v87, 0
    v_mov_b32 v88, 0
    v_mov_b32 v89, 0
    v_mov_b32 v90, 0
    v_mov_b32 v91, 0
    v_mov_b32 v92, 0
    v_mov_b32 v93, 0
    v_mov_b32 v94, 0
    v_mov_b32 v95, 0
    v_mov_b32 v96, 0
    v_mov_b32 v97, 0
    v_mov_b32 v98, 0
    v_mov_b32 v99, 0
    v_mov_b32 v100, 0
    v_mov_b32 v101, 0
    v_mov_b32 v102, 0
    v_mov_b32 v103, 0
    v_mov_b32 v104, 0
    v_mov_b32 v105, 0
    v_mov_b32 v106, 0
    v_mov_b32 v107, 0
    v_mov_b32 v108, 0
    v_mov_b32 v109, 0
    v_mov_b32 v110, 0
    v_mov_b32 v111, 0
    v_mov_b32 v112, 0
    v_mov_b32 v113, 0
    v_mov_b32 v114, 0
    v_mov_b32 v115, 0
    v_mov_b32 v116, 0
    v_mov_b32 v117, 0
    v_mov_b32 v118, 0
    v_mov_b32 v119, 0
    v_mov_b32 v120, 0
    v_mov_b32 v121, 0
    v_mov_b32 v122, 0
    v_mov_b32 v123, 0
    v_mov_b32 v124, 0
    v_mov_b32 v125, 0
    v_mov_b32 v126, 0
    v_mov_b32 v127, 0
    s_and_b32 s31, s26, 1
    s_lshl_b32 s32, s28, 1
    s_add_u32 s29, s31, s32
    s_lshl_b32 s32, s22, 2
    s_add_u32 s33, s29, s32
    s_lshl_b32 s30, s23, 1
    s_add_u32 s30, s30, s27
    s_lshl_b32 s30, s30, 6
    s_lshl_b32 s31, s33, 1
    s_add_u32 s30, s30, s31
    s_lshl_b32 s30, s30, 10
    v_add_u32 v7, s30, v9
    s_mov_b32 s16, s60
    s_and_b32 s17, s61, 0xffff
    s_mov_b32 s18, 0x400000
    s_mov_b32 s19, 0x00020000
    s_add_u32 s56, s6, 0x1400000
    s_addc_u32 s57, s7, 0
    s_and_b32 s57, s57, 0xffff
    s_mov_b32 s58, 0x400000
    s_mov_b32 s59, 0x00020000
    s_mov_b32 s97, -122880
    s_waitcnt vmcnt(12)
    s_barrier
    ds_read_b128 v[128:131], v16 offset:0
    ds_read_b64_tr_b16 v[136:137], v18 offset:0
    ds_read_b64_tr_b16 v[138:139], v18 offset:2048
    ds_read_b64_tr_b16 v[140:141], v19 offset:0
    ds_read_b64_tr_b16 v[142:143], v19 offset:2048
    ds_read_b128 v[132:135], v17 offset:0
    s_mov_b32 s54, 5
L_k2_wo_kernel_loop_2:
    s_waitcnt vmcnt(9)
    s_barrier
    s_add_u32 s53, s53, 24576
    s_cmp_ge_u32 s53, 147456
    s_cselect_b32 s53, 0, s53
    s_cselect_b32 s96, s97, 24576
    v_add_u32 v16, s96, v16
    v_add_u32 v17, s96, v17
    v_add_u32 v18, s96, v18
    v_add_u32 v19, s96, v19
    s_waitcnt lgkmcnt(3)
    v_mfma_f32_32x32x16_bf16 v[64:79], v[136:139], v[128:131], v[64:79]
    ds_read_b128 v[144:147], v16 offset:0
    ds_read_b64_tr_b16 v[152:153], v18 offset:0
    s_add_u32 m0, s52, s40
    s_nop 0
    buffer_load_dwordx4 v10, s[8:11], s50 offen lds
    s_waitcnt lgkmcnt(3)
    v_mfma_f32_32x32x16_bf16 v[80:95], v[140:143], v[128:131], v[80:95]
    ds_read_b64_tr_b16 v[154:155], v18 offset:2048
    s_add_u32 m0, s52, s42
    s_nop 0
    buffer_load_dwordx4 v12, s[12:15], s51 offen lds
    s_waitcnt lgkmcnt(3)
    v_mfma_f32_32x32x16_bf16 v[96:111], v[136:139], v[132:135], v[96:111]
    ds_read_b64_tr_b16 v[156:157], v19 offset:0
    ds_read_b64_tr_b16 v[158:159], v19 offset:2048
    s_add_u32 m0, s52, s43
    s_nop 0
    buffer_load_dwordx4 v13, s[12:15], s51 offen lds
    s_add_u32 s50, s50, 0x1000
    s_add_u32 s51, s51, 0x20000
    s_add_u32 s52, s52, 24576
    s_cmp_ge_u32 s52, 147456
    s_cselect_b32 s52, 0, s52
    v_mfma_f32_32x32x16_bf16 v[112:127], v[140:143], v[132:135], v[112:127]
    ds_read_b128 v[148:151], v17 offset:0
    s_waitcnt vmcnt(9)
    s_barrier
    s_add_u32 s53, s53, 24576
    s_cmp_ge_u32 s53, 147456
    s_cselect_b32 s53, 0, s53
    s_cselect_b32 s96, s97, 24576
    v_add_u32 v16, s96, v16
    v_add_u32 v17, s96, v17
    v_add_u32 v18, s96, v18
    v_add_u32 v19, s96, v19
    s_waitcnt lgkmcnt(3)
    v_mfma_f32_32x32x16_bf16 v[64:79], v[152:155], v[144:147], v[64:79]
    ds_read_b128 v[128:131], v16 offset:0
    ds_read_b64_tr_b16 v[136:137], v18 offset:0
    s_add_u32 m0, s52, s40
    s_nop 0
    buffer_load_dwordx4 v10, s[8:11], s50 offen lds
    s_waitcnt lgkmcnt(3)
    v_mfma_f32_32x32x16_bf16 v[80:95], v[156:159], v[144:147], v[80:95]
    ds_read_b64_tr_b16 v[138:139], v18 offset:2048
    s_add_u32 m0, s52, s42
    s_nop 0
    buffer_load_dwordx4 v12, s[12:15], s51 offen lds
    s_waitcnt lgkmcnt(3)
    v_mfma_f32_32x32x16_bf16 v[96:111], v[152:155], v[148:151], v[96:111]
    ds_read_b64_tr_b16 v[140:141], v19 offset:0
    ds_read_b64_tr_b16 v[142:143], v19 offset:2048
    s_add_u32 m0, s52, s43
    s_nop 0
    buffer_load_dwordx4 v13, s[12:15], s51 offen lds
    s_add_u32 s50, s50, 0x1000
    s_add_u32 s51, s51, 0x20000
    s_add_u32 s52, s52, 24576
    s_cmp_ge_u32 s52, 147456
    s_cselect_b32 s52, 0, s52
    v_mfma_f32_32x32x16_bf16 v[112:127], v[156:159], v[148:151], v[112:127]
    ds_read_b128 v[132:135], v17 offset:0
    s_sub_u32 s54, s54, 1
    s_cmp_lg_u32 s54, 0
    s_cbranch_scc1 L_k2_wo_kernel_loop_2
    s_waitcnt vmcnt(9)
    s_barrier
    s_add_u32 s53, s53, 24576
    s_cmp_ge_u32 s53, 147456
    s_cselect_b32 s53, 0, s53
    s_cselect_b32 s96, s97, 24576
    v_add_u32 v16, s96, v16
    v_add_u32 v17, s96, v17
    v_add_u32 v18, s96, v18
    v_add_u32 v19, s96, v19
    s_waitcnt lgkmcnt(3)
    v_mfma_f32_32x32x16_bf16 v[64:79], v[136:139], v[128:131], v[64:79]
    ds_read_b128 v[144:147], v16 offset:0
    ds_read_b64_tr_b16 v[152:153], v18 offset:0
    s_add_u32 m0, s52, s40
    s_nop 0
    buffer_load_dwordx4 v10, s[8:11], s50 offen lds
    s_waitcnt lgkmcnt(3)
    v_mfma_f32_32x32x16_bf16 v[80:95], v[140:143], v[128:131], v[80:95]
    ds_read_b64_tr_b16 v[154:155], v18 offset:2048
    s_add_u32 m0, s52, s42
    s_nop 0
    buffer_load_dwordx4 v12, s[12:15], s51 offen lds
    s_waitcnt lgkmcnt(3)
    v_mfma_f32_32x32x16_bf16 v[96:111], v[136:139], v[132:135], v[96:111]
    ds_read_b64_tr_b16 v[156:157], v19 offset:0
    ds_read_b64_tr_b16 v[158:159], v19 offset:2048
    s_add_u32 m0, s52, s43
    s_nop 0
    buffer_load_dwordx4 v13, s[12:15], s51 offen lds
    s_add_u32 s50, s50, 0x1000
    s_add_u32 s51, s51, 0x20000
    s_add_u32 s52, s52, 24576
    s_cmp_ge_u32 s52, 147456
    s_cselect_b32 s52, 0, s52
    v_mfma_f32_32x32x16_bf16 v[112:127], v[140:143], v[132:135], v[112:127]
    ds_read_b128 v[148:151], v17 offset:0
    s_waitcnt vmcnt(9)
    s_barrier
    s_add_u32 s53, s53, 24576
    s_cmp_ge_u32 s53, 147456
    s_cselect_b32 s53, 0, s53
    s_cselect_b32 s96, s97, 24576
    v_add_u32 v16, s96, v16
    v_add_u32 v17, s96, v17
    v_add_u32 v18, s96, v18
    v_add_u32 v19, s96, v19
    s_waitcnt lgkmcnt(3)
    v_mfma_f32_32x32x16_bf16 v[64:79], v[152:155], v[144:147], v[64:79]
    ds_read_b128 v[128:131], v16 offset:0
    ds_read_b64_tr_b16 v[136:137], v18 offset:0
    s_waitcnt lgkmcnt(3)
    v_mfma_f32_32x32x16_bf16 v[80:95], v[156:159], v[144:147], v[80:95]
    ds_read_b64_tr_b16 v[138:139], v18 offset:2048
    s_waitcnt lgkmcnt(3)
    v_mfma_f32_32x32x16_bf16 v[96:111], v[152:155], v[148:151], v[96:111]
    ds_read_b64_tr_b16 v[140:141], v19 offset:0
    ds_read_b64_tr_b16 v[142:143], v19 offset:2048
    v_mfma_f32_32x32x16_bf16 v[112:127], v[156:159], v[148:151], v[112:127]
    ds_read_b128 v[132:135], v17 offset:0
    s_lshl_b32 s30, s27, 5
    s_add_u32 s30, s30, s24
    v_and_b32 v3, 31, v2
    v_add_u32 v3, s30, v3
    v_lshlrev_b32 v6, 11, v3
    s_lshl_b32 s32, s33, 6
    v_add_u32 v6, s32, v6
    v_lshrrev_b32 v5, 5, v2
    v_lshl_add_u32 v6, v5, 3, v6
    buffer_load_dwordx2 v[32:33], v6, s[16:19], 0 offen offset:0
    buffer_load_dwordx2 v[34:35], v6, s[16:19], 0 offen offset:16
    buffer_load_dwordx2 v[36:37], v6, s[16:19], 0 offen offset:32
    buffer_load_dwordx2 v[38:39], v6, s[16:19], 0 offen offset:48
    s_waitcnt vmcnt(10)
    s_barrier
    s_add_u32 s53, s53, 24576
    s_cmp_ge_u32 s53, 147456
    s_cselect_b32 s53, 0, s53
    s_cselect_b32 s96, s97, 24576
    v_add_u32 v16, s96, v16
    v_add_u32 v17, s96, v17
    v_add_u32 v18, s96, v18
    v_add_u32 v19, s96, v19
    s_waitcnt lgkmcnt(3)
    v_mfma_f32_32x32x16_bf16 v[64:79], v[136:139], v[128:131], v[64:79]
    ds_read_b128 v[144:147], v16 offset:0
    ds_read_b64_tr_b16 v[152:153], v18 offset:0
    s_waitcnt lgkmcnt(3)
    v_mfma_f32_32x32x16_bf16 v[80:95], v[140:143], v[128:131], v[80:95]
    ds_read_b64_tr_b16 v[154:155], v18 offset:2048
    s_waitcnt lgkmcnt(3)
    v_mfma_f32_32x32x16_bf16 v[96:111], v[136:139], v[132:135], v[96:111]
    ds_read_b64_tr_b16 v[156:157], v19 offset:0
    ds_read_b64_tr_b16 v[158:159], v19 offset:2048
    v_mfma_f32_32x32x16_bf16 v[112:127], v[140:143], v[132:135], v[112:127]
    ds_read_b128 v[148:151], v17 offset:0
    s_waitcnt vmcnt(7)
    s_barrier
    s_add_u32 s53, s53, 24576
    s_cmp_ge_u32 s53, 147456
    s_cselect_b32 s53, 0, s53
    s_cselect_b32 s96, s97, 24576
    v_add_u32 v16, s96, v16
    v_add_u32 v17, s96, v17
    v_add_u32 v18, s96, v18
    v_add_u32 v19, s96, v19
    s_waitcnt lgkmcnt(3)
    v_mfma_f32_32x32x16_bf16 v[64:79], v[152:155], v[144:147], v[64:79]
    ds_read_b128 v[128:131], v16 offset:0
    ds_read_b64_tr_b16 v[136:137], v18 offset:0
    s_waitcnt lgkmcnt(3)
    v_mfma_f32_32x32x16_bf16 v[80:95], v[156:159], v[144:147], v[80:95]
    ds_read_b64_tr_b16 v[138:139], v18 offset:2048
    s_waitcnt lgkmcnt(3)
    v_mfma_f32_32x32x16_bf16 v[96:111], v[152:155], v[148:151], v[96:111]
    ds_read_b64_tr_b16 v[140:141], v19 offset:0
    ds_read_b64_tr_b16 v[142:143], v19 offset:2048
    v_mfma_f32_32x32x16_bf16 v[112:127], v[156:159], v[148:151], v[112:127]
    ds_read_b128 v[132:135], v17 offset:0
    s_waitcnt vmcnt(4)
    s_barrier
    s_add_u32 s53, s53, 24576
    s_cmp_ge_u32 s53, 147456
    s_cselect_b32 s53, 0, s53
    s_cselect_b32 s96, s97, 24576
    v_add_u32 v16, s96, v16
    v_add_u32 v17, s96, v17
    v_add_u32 v18, s96, v18
    v_add_u32 v19, s96, v19
    s_waitcnt lgkmcnt(3)
    v_mfma_f32_32x32x16_bf16 v[64:79], v[136:139], v[128:131], v[64:79]
    ds_read_b128 v[144:147], v16 offset:0
    ds_read_b64_tr_b16 v[152:153], v18 offset:0
    s_waitcnt lgkmcnt(3)
    v_mfma_f32_32x32x16_bf16 v[80:95], v[140:143], v[128:131], v[80:95]
    ds_read_b64_tr_b16 v[154:155], v18 offset:2048
    s_waitcnt lgkmcnt(3)
    v_mfma_f32_32x32x16_bf16 v[96:111], v[136:139], v[132:135], v[96:111]
    ds_read_b64_tr_b16 v[156:157], v19 offset:0
    ds_read_b64_tr_b16 v[158:159], v19 offset:2048
    v_mfma_f32_32x32x16_bf16 v[112:127], v[140:143], v[132:135], v[112:127]
    ds_read_b128 v[148:151], v17 offset:0
    s_waitcnt vmcnt(4)
    s_barrier
    s_waitcnt lgkmcnt(3)
    v_mfma_f32_32x32x16_bf16 v[64:79], v[152:155], v[144:147], v[64:79]
    s_waitcnt lgkmcnt(1)
    v_mfma_f32_32x32x16_bf16 v[80:95], v[156:159], v[144:147], v[80:95]
    s_waitcnt lgkmcnt(0)
    v_mfma_f32_32x32x16_bf16 v[96:111], v[152:155], v[148:151], v[96:111]
    v_mfma_f32_32x32x16_bf16 v[112:127], v[156:159], v[148:151], v[112:127]
    s_xor_b32 s30, s26, 1
    s_lshl_b32 s34, s28, 2
    s_add_u32 s30, s30, s34
    s_mul_i32 s30, s30, 3
    s_add_u32 s30, s30, 0
    s_lshl_b32 s30, s30, 12
    v_add_u32 v21, s30, v9
    s_xor_b32 s30, s26, 2
    s_lshl_b32 s34, s28, 2
    s_add_u32 s30, s30, s34
    s_mul_i32 s30, s30, 3
    s_add_u32 s30, s30, 1
    s_lshl_b32 s30, s30, 12
    v_add_u32 v22, s30, v9
    s_xor_b32 s30, s26, 3
    s_lshl_b32 s34, s28, 2
    s_add_u32 s30, s30, s34
    s_mul_i32 s30, s30, 3
    s_add_u32 s30, s30, 2
    s_lshl_b32 s30, s30, 12
    v_add_u32 v23, s30, v9
    s_lshl_b32 s34, s28, 2
    s_add_u32 s30, s26, s34
    s_mul_i32 s30, s30, 12288
    v_add_u32 v20, s30, v9
    v_mov_b32 v60, 0xffff0000
    s_nop 4
    s_barrier
    ds_write_b128 v21, v[80:83] offset:0
    ds_write_b128 v21, v[84:87] offset:1024
    ds_write_b128 v21, v[88:91] offset:2048
    ds_write_b128 v21, v[92:95] offset:3072
    ds_write_b128 v22, v[96:99] offset:0
    ds_write_b128 v22, v[100:103] offset:1024
    ds_write_b128 v22, v[104:107] offset:2048
    ds_write_b128 v22, v[108:111] offset:3072
    ds_write_b128 v23, v[112:115] offset:0
    ds_write_b128 v23, v[116:119] offset:1024
    ds_write_b128 v23, v[120:123] offset:2048
    ds_write_b128 v23, v[124:127] offset:3072
    s_waitcnt lgkmcnt(0)
    s_barrier
    ds_read_b128 v[80:83], v20 offset:0
    ds_read_b128 v[84:87], v20 offset:1024
    ds_read_b128 v[88:91], v20 offset:2048
    ds_read_b128 v[92:95], v20 offset:3072
    ds_read_b128 v[96:99], v20 offset:4096
    ds_read_b128 v[100:103], v20 offset:5120
    ds_read_b128 v[104:107], v20 offset:6144
    ds_read_b128 v[108:111], v20 offset:7168
    ds_read_b128 v[112:115], v20 offset:8192
    ds_read_b128 v[116:119], v20 offset:9216
    ds_read_b128 v[120:123], v20 offset:10240
    ds_read_b128 v[124:127], v20 offset:11264
    s_waitcnt lgkmcnt(8)
    v_pk_add_f32 v[64:65], v[64:65], v[80:81]
    v_pk_add_f32 v[66:67], v[66:67], v[82:83]
    v_pk_add_f32 v[68:69], v[68:69], v[84:85]
    v_pk_add_f32 v[70:71], v[70:71], v[86:87]
    v_pk_add_f32 v[72:73], v[72:73], v[88:89]
    v_pk_add_f32 v[74:75], v[74:75], v[90:91]
    v_pk_add_f32 v[76:77], v[76:77], v[92:93]
    v_pk_add_f32 v[78:79], v[78:79], v[94:95]
    s_waitcnt lgkmcnt(0)
    v_pk_add_f32 v[96:97], v[96:97], v[112:113]
    v_pk_add_f32 v[98:99], v[98:99], v[114:115]
    v_pk_add_f32 v[100:101], v[100:101], v[116:117]
    v_pk_add_f32 v[102:103], v[102:103], v[118:119]
    v_pk_add_f32 v[104:105], v[104:105], v[120:121]
    v_pk_add_f32 v[106:107], v[106:107], v[122:123]
    v_pk_add_f32 v[108:109], v[108:109], v[124:125]
    v_pk_add_f32 v[110:111], v[110:111], v[126:127]
    v_pk_add_f32 v[64:65], v[64:65], v[96:97]
    v_pk_add_f32 v[66:67], v[66:67], v[98:99]
    v_pk_add_f32 v[68:69], v[68:69], v[100:101]
    v_pk_add_f32 v[70:71], v[70:71], v[102:103]
    v_pk_add_f32 v[72:73], v[72:73], v[104:105]
    v_pk_add_f32 v[74:75], v[74:75], v[106:107]
    v_pk_add_f32 v[76:77], v[76:77], v[108:109]
    v_pk_add_f32 v[78:79], v[78:79], v[110:111]
    s_waitcnt vmcnt(0)
    v_cvt_pk_bf16_f32 v40, v64, v65
    v_cvt_pk_bf16_f32 v41, v66, v67
    v_cvt_pk_bf16_f32 v42, v68, v69
    v_cvt_pk_bf16_f32 v43, v70, v71
    v_cvt_pk_bf16_f32 v44, v72, v73
    v_cvt_pk_bf16_f32 v45, v74, v75
    v_cvt_pk_bf16_f32 v46, v76, v77
    v_cvt_pk_bf16_f32 v47, v78, v79
    v_lshlrev_b32 v80, 16, v40
    v_and_b32 v81, v60, v40
    v_lshlrev_b32 v96, 16, v32
    v_and_b32 v97, v60, v32
    v_lshlrev_b32 v82, 16, v41
    v_and_b32 v83, v60, v41
    v_lshlrev_b32 v98, 16, v33
    v_and_b32 v99, v60, v33
    v_lshlrev_b32 v84, 16, v42
    v_and_b32 v85, v60, v42
    v_lshlrev_b32 v100, 16, v34
    v_and_b32 v101, v60, v34
    v_lshlrev_b32 v86, 16, v43
    v_and_b32 v87, v60, v43
    v_lshlrev_b32 v102, 16, v35
    v_and_b32 v103, v60, v35
    v_lshlrev_b32 v88, 16, v44
    v_and_b32 v89, v60, v44
    v_lshlrev_b32 v104, 16, v36
    v_and_b32 v105, v60, v36
    v_lshlrev_b32 v90, 16, v45
    v_and_b32 v91, v60, v45
    v_lshlrev_b32 v106, 16, v37
    v_and_b32 v107, v60, v37
    v_lshlrev_b32 v92, 16, v46
    v_and_b32 v93, v60, v46
    v_lshlrev_b32 v108, 16, v38
    v_and_b32 v109, v60, v38
    v_lshlrev_b32 v94, 16, v47
    v_and_b32 v95, v60, v47
    v_lshlrev_b32 v110, 16, v39
    v_and_b32 v111, v60, v39
    v_pk_add_f32 v[80:81], v[80:81], v[96:97]
    v_pk_add_f32 v[82:83], v[82:83], v[98:99]
    v_pk_add_f32 v[84:85], v[84:85], v[100:101]
    v_pk_add_f32 v[86:87], v[86:87], v[102:103]
    v_pk_add_f32 v[88:89], v[88:89], v[104:105]
    v_pk_add_f32 v[90:91], v[90:91], v[106:107]
    v_pk_add_f32 v[92:93], v[92:93], v[108:109]
    v_pk_add_f32 v[94:95], v[94:95], v[110:111]
    v_cvt_pk_bf16_f32 v48, v80, v81
    v_cvt_pk_bf16_f32 v49, v82, v83
    v_cvt_pk_bf16_f32 v50, v84, v85
    v_cvt_pk_bf16_f32 v51, v86, v87
    v_cvt_pk_bf16_f32 v52, v88, v89
    v_cvt_pk_bf16_f32 v53, v90, v91
    v_cvt_pk_bf16_f32 v54, v92, v93
    v_cvt_pk_bf16_f32 v55, v94, v95
    buffer_store_dwordx4 v[48:51], v7, s[56:59], 0 offen offset:0 sc1
    buffer_store_dwordx4 v[52:55], v7, s[56:59], 0 offen offset:1024 sc1
    v_lshlrev_b32 v80, 16, v48
    v_and_b32 v81, v60, v48
    v_lshlrev_b32 v82, 16, v49
    v_and_b32 v83, v60, v49
    v_lshlrev_b32 v84, 16, v50
    v_and_b32 v85, v60, v50
    v_lshlrev_b32 v86, 16, v51
    v_and_b32 v87, v60, v51
    v_lshlrev_b32 v88, 16, v52
    v_and_b32 v89, v60, v52
    v_lshlrev_b32 v90, 16, v53
    v_and_b32 v91, v60, v53
    v_lshlrev_b32 v92, 16, v54
    v_and_b32 v93, v60, v54
    v_lshlrev_b32 v94, 16, v55
    v_and_b32 v95, v60, v55
    v_pk_mul_f32 v[96:97], v[80:81], v[80:81]
    v_pk_mul_f32 v[98:99], v[82:83], v[82:83]
    v_pk_mul_f32 v[100:101], v[84:85], v[84:85]
    v_pk_mul_f32 v[102:103], v[86:87], v[86:87]
    v_pk_mul_f32 v[104:105], v[88:89], v[88:89]
    v_pk_mul_f32 v[106:107], v[90:91], v[90:91]
    v_pk_mul_f32 v[108:109], v[92:93], v[92:93]
    v_pk_mul_f32 v[110:111], v[94:95], v[94:95]
    v_pk_add_f32 v[80:81], v[80:81], v[88:89]
    v_pk_add_f32 v[96:97], v[96:97], v[104:105]
    v_pk_add_f32 v[82:83], v[82:83], v[90:91]
    v_pk_add_f32 v[98:99], v[98:99], v[106:107]
    v_pk_add_f32 v[84:85], v[84:85], v[92:93]
    v_pk_add_f32 v[100:101], v[100:101], v[108:109]
    v_pk_add_f32 v[86:87], v[86:87], v[94:95]
    v_pk_add_f32 v[102:103], v[102:103], v[110:111]
    v_pk_add_f32 v[80:81], v[80:81], v[84:85]
    v_pk_add_f32 v[96:97], v[96:97], v[100:101]
    v_pk_add_f32 v[82:83], v[82:83], v[86:87]
    v_pk_add_f32 v[98:99], v[98:99], v[102:103]
    v_pk_add_f32 v[80:81], v[80:81], v[82:83]
    v_pk_add_f32 v[96:97], v[96:97], v[98:99]
    v_add_f32 v44, v80, v81
    v_add_f32 v45, v96, v97
    v_mov_b32 v46, v44
    v_mov_b32 v47, v45
    s_nop 1
    v_permlane32_swap_b32 v44, v46
    v_permlane32_swap_b32 v45, v47
    s_nop 1
    v_add_f32 v44, v44, v46
    v_add_f32 v45, v45, v47
    s_lshl_b32 s30, s27, 2
    s_add_u32 s30, s30, s29
    s_lshl_b32 s30, s30, 8
    s_add_u32 s30, s30, 98304
    v_and_b32 v3, 31, v2
    v_lshlrev_b32 v3, 3, v3
    v_add_u32 v4, s30, v3
    ds_write_b64 v4, v[44:45]
    s_add_u32 s16, s6, 0xc00000
    s_addc_u32 s17, s7, 0
    s_and_b32 s17, s17, 0xffff
    s_mov_b32 s18, 0x20000
    s_mov_b32 s19, 0x00020000
    s_waitcnt lgkmcnt(0)
    s_barrier
    s_cmp_ge_u32 s25, 2
    s_cbranch_scc1 L_k2_wo_kernel_fin_3
    s_lshl_b32 s30, s25, 10
    s_add_u32 s30, s30, 98304
    v_add_u32 v4, s30, v3
    ds_read_b64 v[44:45], v4 offset:0
    ds_read_b64 v[46:47], v4 offset:256
    ds_read_b64 v[48:49], v4 offset:512
    ds_read_b64 v[50:51], v4 offset:768
    s_lshl_b32 s30, s22, 14
    s_lshl_b32 s31, s25, 5
    s_add_u32 s31, s31, s24
    s_lshl_b32 s31, s31, 3
    s_add_u32 s30, s30, s31
    v_add_u32 v3, s30, v3
    s_waitcnt lgkmcnt(0)
    v_pk_add_f32 v[44:45], v[44:45], v[46:47]
    v_pk_add_f32 v[48:49], v[48:49], v[50:51]
    v_pk_add_f32 v[44:45], v[44:45], v[48:49]
    v_cmp_gt_u32 vcc, 32, v2
    s_and_saveexec_b64 s[36:37], vcc
    buffer_store_dwordx2 v[44:45], v3, s[16:19], 0 offen sc1
L_k2_wo_kernel_fin_3:
L_k2_wo_kernel_end_1:
    s_endpgm
.globl k3_glu_kernel
.p2align 8
.type k3_glu_kernel,@function
k3_glu_kernel:
    s_cmp_ge_u32 s2, 256
    s_cbranch_scc1 L_k3_glu_kernel_end_1
    s_load_dwordx4 s[60:63], s[0:1], 32
    s_load_dwordx2 s[6:7], s[0:1], 72
    s_load_dwordx2 s[70:71], s[0:1], 48
    s_and_b32 s20, s2, 7
    s_lshr_b32 s21, s2, 3
    s_lshr_b32 s23, s20, 2
    s_lshl_b32 s23, s23, 2
    s_and_b32 s24, s21, 3
    s_add_u32 s23, s23, s24
    s_and_b32 s22, s20, 3
    s_lshl_b32 s22, s22, 3
    s_lshr_b32 s24, s21, 2
    s_add_u32 s22, s22, s24
    s_lshl_b32 s24, s23, 8
    v_lshrrev_b32 v1, 6, v0
    v_and_b32 v2, 63, v0
    s_nop 0
    v_readfirstlane_b32 s25, v1
    v_lshlrev_b32 v9, 4, v2
    s_lshl_b32 s29, s23, 3
    s_add_u32 s29, s29, s25
    s_lshl_b32 s30, s29, 16
    v_add_u32 v10, s30, v9
    v_add_u32 v11, 1024, v10
    s_lshl_b32 s40, s25, 11
    s_add_u32 s40, s40, 0
    s_lshl_b32 s41, s25, 11
    s_add_u32 s41, s41, 1024
    s_lshl_b32 s31, s25, 3
    v_lshrrev_b32 v3, 3, v2
    v_add_u32 v3, s31, v3
    v_mul_u32_u24 v4, 37, v3
    v_lshrrev_b32 v4, 8, v4
    v_mul_u32_u24 v5, 7, v4
    v_sub_u32 v5, v3, v5
    v_bfe_u32 v6, v2, 1, 2
    v_lshl_add_u32 v6, v4, 2, v6
    v_mul_u32_u24 v6, 7168, v6
    v_lshl_add_u32 v6, v5, 5, v6
    v_and_b32 v7, 1, v2
    v_lshl_add_u32 v6, v7, 4, v6
    s_mul_i32 s31, s22, 224
    v_add_u32 v12, s31, v6
    s_mul_i32 s31, s2, 28672
    v_add_u32 v7, s31, v9
    s_lshl_b32 s42, s25, 10
    s_add_u32 s43, s42, 23680
    s_add_u32 s42, s42, 16384
    s_mov_b32 s56, 229376
    s_cmp_eq_u32 s25, 7
    s_cselect_b32 s56, 1024, s56
    s_cselect_b32 s57, 0, -1
    s_cselect_b32 s42, 155904, s42
    s_cselect_b32 s43, 156928, s43
    s_cselect_b64 vcc, -1, 0
    s_nop 1
    v_cndmask_b32 v12, v12, v7, vcc
    s_mov_b32 s50, 0
    s_mov_b32 s51, 0
    s_waitcnt lgkmcnt(0)
    s_add_u32 s8, s6, 0x1400000
    s_addc_u32 s9, s7, 0
    s_and_b32 s9, s9, 0xffff
    s_mov_b32 s10, 0x400000
    s_mov_b32 s11, 0x00020000
    s_cmp_eq_u32 s25, 7
    s_cselect_b32 s72, s70, s60
    s_cselect_b32 s73, s71, s61
    s_cselect_b32 s74, s70, s62
    s_cselect_b32 s75, s71, s63
    s_mov_b32 s12, s72
    s_and_b32 s13, s73, 0xffff
    s_mov_b32 s14, 0x700000
    s_mov_b32 s15, 0x00020000
    s_mov_b32 s16, s74
    s_and_b32 s17, s75, 0xffff
    s_mov_b32 s18, 0x700000
    s_mov_b32 s19, 0x00020000
    s_cmp_eq_u32 s25, 7
    s_cselect_b32 s14, 0, s14
    s_cselect_b32 s18, 0, s18
    s_mov_b32 s52, 0
    s_mov_b32 s53, 0
    s_add_u32 m0, s52, s40
    s_nop 0
    buffer_load_dwordx4 v10, s[8:11], s50 offen lds
    s_add_u32 m0, s52, s41
    s_nop 0
    buffer_load_dwordx4 v11, s[8:11], s50 offen lds
    s_and_b32 s95, s52, s57
    s_add_u32 m0, s95, s42
    s_nop 0
    buffer_load_dwordx4 v12, s[12:15], s51 offen lds
    s_and_b32 s95, s52, s57
    s_add_u32 m0, s95, s43
    s_nop 0
    buffer_load_dwordx4 v12, s[16:19], s51 offen lds
    s_add_u32 s50, s50, 0x800
    s_add_u32 s51, s51, s56
    s_add_u32 s52, s52, 30976
    s_cmp_ge_u32 s52, 154880
    s_cselect_b32 s52, 0, s52
    s_add_u32 m0, s52, s40
    s_nop 0
    buffer_load_dwordx4 v10, s[8:11], s50 offen lds
    s_add_u32 m0, s52, s41
    s_nop 0
    buffer_load_dwordx4 v11, s[8:11], s50 offen lds
    s_and_b32 s95, s52, s57
    s_add_u32 m0, s95, s42
    s_nop 0
    buffer_load_dwordx4 v12, s[12:15], s51 offen lds
    s_and_b32 s95, s52, s57
    s_add_u32 m0, s95, s43
    s_nop 0
    buffer_load_dwordx4 v12, s[16:19], s51 offen lds
    s_add_u32 s50, s50, 0x800
    s_add_u32 s51, s51, s56
    s_add_u32 s52, s52, 30976
    s_cmp_ge_u32 s52, 154880
    s_cselect_b32 s52, 0, s52
    s_add_u32 m0, s52, s40
    s_nop 0
    buffer_load_dwordx4 v10, s[8:11], s50 offen lds
    s_add_u32 m0, s52, s41
    s_nop 0
    buffer_load_dwordx4 v11, s[8:11], s50 offen lds
    s_and_b32 s95, s52, s57
    s_add_u32 m0, s95, s42
    s_nop 0
    buffer_load_dwordx4 v12, s[12:15], s51 offen lds
    s_and_b32 s95, s52, s57
    s_add_u32 m0, s95, s43
    s_nop 0
    buffer_load_dwordx4 v12, s[16:19], s51 offen lds
    s_add_u32 s50, s50, 0x800
    s_add_u32 s51, s51, s56
    s_add_u32 s52, s52, 30976
    s_cmp_ge_u32 s52, 154880
    s_cselect_b32 s52, 0, s52
    s_add_u32 m0, s52, s40
    s_nop 0
    buffer_load_dwordx4 v10, s[8:11], s50 offen lds
    s_add_u32 m0, s52, s41
    s_nop 0
    buffer_load_dwordx4 v11, s[8:11], s50 offen lds
    s_and_b32 s95, s52, s57
    s_add_u32 m0, s95, s42
    s_nop 0
    buffer_load_dwordx4 v12, s[12:15], s51 offen lds
    s_and_b32 s95, s52, s57
    s_add_u32 m0, s95, s43
    s_nop 0
    buffer_load_dwordx4 v12, s[16:19], s51 offen lds
    s_add_u32 s50, s50, 0x800
    s_add_u32 s51, s51, s56
    s_add_u32 s52, s52, 30976
    s_cmp_ge_u32 s52, 154880
    s_cselect_b32 s52, 0, s52
    s_mov_b32 s14, 7340032
    s_cmp_eq_u32 s25, 7
    s_cselect_b32 s51, 0, s51
    s_and_b32 s26, s25, 3
    s_lshr_b32 s27, s25, 2
    s_lshl_b32 s30, s26, 12
    v_add_u32 v14, s30, v9
    v_bfe_u32 v3, v2, 2, 2
    v_lshlrev_b32 v3, 5, v3
    v_and_b32 v4, 3, v2
    v_lshl_add_u32 v3, v4, 3, v3
    v_lshrrev_b32 v4, 5, v2
    v_mul_u32_u24 v4, 896, v4
    v_add_u32 v3, v3, v4
    v_bfe_u32 v4, v2, 4, 1
    v_mul_u32_u24 v4, 7296, v4
    v_add_u32 v3, v3, v4
    s_lshl_b32 s30, s27, 9
    s_add_u32 s30, s30, 16384
    v_add_u32 v16, s30, v3
    v_mov_b32 v64, 0
    v_mov_b32 v65, 0
    v_mov_b32 v66, 0
    v_mov_b32 v67, 0
    v_mov_b32 v68, 0
    v_mov_b32 v69, 0
    v_mov_b32 v70, 0
    v_mov_b32 v71, 0
    v_mov_b32 v72, 0
    v_mov_b32 v73, 0
    v_mov_b32 v74, 0
    v_mov_b32 v75, 0
    v_mov_b32 v76, 0
    v_mov_b32 v77, 0
    v_mov_b32 v78, 0
    v_mov_b32 v79, 0
    v_mov_b32 v80, 0
    v_mov_b32 v81, 0
    v_mov_b32 v82, 0
    v_mov_b32 v83, 0
    v_mov_b32 v84, 0
    v_mov_b32 v85, 0
    v_mov_b32 v86, 0
    v_mov_b32 v87, 0
    v_mov_b32 v88, 0
    v_mov_b32 v89, 0
    v_mov_b32 v90, 0
    v_mov_b32 v91, 0
    v_mov_b32 v92, 0
    v_mov_b32 v93, 0
    v_mov_b32 v94, 0
    v_mov_b32 v95, 0
    v_mov_b32 v96, 0
    v_mov_b32 v97, 0
    v_mov_b32 v98, 0
    v_mov_b32 v99, 0
    v_mov_b32 v100, 0
    v_mov_b32 v101, 0
    v_mov_b32 v102, 0
    v_mov_b32 v103, 0
    v_mov_b32 v104, 0
    v_mov_b32 v105, 0
    v_mov_b32 v106, 0
    v_mov_b32 v107, 0
    v_mov_b32 v108, 0
    v_mov_b32 v109, 0
    v_mov_b32 v110, 0
    v_mov_b32 v111, 0
    v_mov_b32 v112, 0
    v_mov_b32 v113, 0
    v_mov_b32 v114, 0
    v_mov_b32 v115, 0
    v_mov_b32 v116, 0
    v_mov_b32 v117, 0
    v_mov_b32 v118, 0
    v_mov_b32 v119, 0
    v_mov_b32 v120, 0
    v_mov_b32 v121, 0
    v_mov_b32 v122, 0
    v_mov_b32 v123, 0
    v_mov_b32 v124, 0
    v_mov_b32 v125, 0
    v_mov_b32 v126, 0
    v_mov_b32 v127, 0
    v_mov_b32 v128, 0
    v_mov_b32 v129, 0
    v_mov_b32 v130, 0
    v_mov_b32 v131, 0
    v_mov_b32 v132, 0
    v_mov_b32 v133, 0
    v_mov_b32 v134, 0
    v_mov_b32 v135, 0
    v_mov_b32 v136, 0
    v_mov_b32 v137, 0
    v_mov_b32 v138, 0
    v_mov_b32 v139, 0
    v_mov_b32 v140, 0
    v_mov_b32 v141, 0
    v_mov_b32 v142, 0
    v_mov_b32 v143, 0
    v_mov_b32 v144, 0
    v_mov_b32 v145, 0
    v_mov_b32 v146, 0
    v_mov_b32 v147, 0
    v_mov_b32 v148, 0
    v_mov_b32 v149, 0
    v_mov_b32 v150, 0
    v_mov_b32 v151, 0
    v_mov_b32 v152, 0
    v_mov_b32 v153, 0
    v_mov_b32 v154, 0
    v_mov_b32 v155, 0
    v_mov_b32 v156, 0
    v_mov_b32 v157, 0
    v_mov_b32 v158, 0
    v_mov_b32 v159, 0
    v_mov_b32 v160, 0
    v_mov_b32 v161, 0
    v_mov_b32 v162, 0
    v_mov_b32 v163, 0
    v_mov_b32 v164, 0
    v_mov_b32 v165, 0
    v_mov_b32 v166, 0
    v_mov_b32 v167, 0
    v_mov_b32 v168, 0
    v_mov_b32 v169, 0
    v_mov_b32 v170, 0
    v_mov_b32 v171, 0
    v_mov_b32 v172, 0
    v_mov_b32 v173, 0
    v_mov_b32 v174, 0
    v_mov_b32 v175, 0
    v_mov_b32 v176, 0
    v_mov_b32 v177, 0
    v_mov_b32 v178, 0
    v_mov_b32 v179, 0
    v_mov_b32 v180, 0
    v_mov_b32 v181, 0
    v_mov_b32 v182, 0
    v_mov_b32 v183, 0
    v_mov_b32 v184, 0
    v_mov_b32 v185, 0
    v_mov_b32 v186, 0
    v_mov_b32 v187, 0
    v_mov_b32 v188, 0
    v_mov_b32 v189, 0
    v_mov_b32 v190, 0
    v_mov_b32 v191, 0
    s_add_u32 s64, s6, 0xc00000
    s_addc_u32 s65, s7, 0
    s_and_b32 s65, s65, 0xffff
    s_mov_b32 s66, 0x20000
    s_mov_b32 s67, 0x00020000
    s_add_u32 s76, s6, 0x1800000
    s_addc_u32 s77, s7, 0
    s_and_b32 s77, s77, 0xffff
    s_mov_b32 s78, 0xe00000
    s_mov_b32 s79, 0x00020000
    s_add_u32 s68, s6, 0xb00000
    s_addc_u32 s69, s7, 0
    s_and_b32 s69, s69, 0xffff
    s_mov_b32 s70, 0x1c000
    s_mov_b32 s71, 0x00020000
    s_cmp_lg_u32 s27, 0
    s_cbranch_scc1 L_k3_glu_kernel_pathb_2
    s_mov_b32 s97, -123904
    s_waitcnt vmcnt(12)
    s_barrier
    ds_read_b128 v[192:195], v14 offset:0
    ds_read_b64_tr_b16 v[200:201], v16 offset:0
    ds_read_b64_tr_b16 v[202:203], v16 offset:1792
    ds_read_b128 v[196:199], v14 offset:2048
    ds_read_b64_tr_b16 v[204:205], v16 offset:128
    ds_read_b64_tr_b16 v[206:207], v16 offset:1920
    ds_read_b64_tr_b16 v[208:209], v16 offset:256
    ds_read_b64_tr_b16 v[210:211], v16 offset:2048
    ds_read_b64_tr_b16 v[212:213], v16 offset:384
    ds_read_b64_tr_b16 v[214:215], v16 offset:2176
    s_mov_b32 s54, 28
L_k3_glu_kernel_loop_4:
    s_waitcnt vmcnt(8)
    s_barrier
    s_waitcnt lgkmcnt(7)
    v_mfma_f32_32x32x16_bf16 v[64:79], v[200:203], v[192:195], v[64:79]
    ds_read_b128 v[216:219], v14 offset:1024
    ds_read_b64_tr_b16 v[224:225], v16 offset:3584
    s_add_u32 m0, s52, s40
    s_nop 0
    buffer_load_dwordx4 v10, s[8:11], s50 offen lds
    s_waitcnt lgkmcnt(8)
    v_mfma_f32_32x32x16_bf16 v[80:95], v[200:203], v[196:199], v[80:95]
    ds_read_b64_tr_b16 v[226:227], v16 offset:5376
    s_add_u32 m0, s52, s41
    s_nop 0
    buffer_load_dwordx4 v11, s[8:11], s50 offen lds
    s_waitcnt lgkmcnt(7)
    v_mfma_f32_32x32x16_bf16 v[96:111], v[204:207], v[192:195], v[96:111]
    ds_read_b128 v[220:223], v14 offset:3072
    s_and_b32 s95, s52, s57
    s_add_u32 m0, s95, s42
    s_nop 0
    buffer_load_dwordx4 v12, s[12:15], s51 offen lds
    v_mfma_f32_32x32x16_bf16 v[112:127], v[204:207], v[196:199], v[112:127]
    ds_read_b64_tr_b16 v[228:229], v16 offset:3712
    s_and_b32 s95, s52, s57
    s_add_u32 m0, s95, s43
    s_nop 0
    buffer_load_dwordx4 v12, s[16:19], s51 offen lds
    s_add_u32 s50, s50, 0x800
    s_add_u32 s51, s51, s56
    s_add_u32 s52, s52, 30976
    s_cmp_ge_u32 s52, 154880
    s_cselect_b32 s52, 0, s52
    s_waitcnt lgkmcnt(7)
    v_mfma_f32_32x32x16_bf16 v[128:143], v[208:211], v[192:195], v[128:143]
    ds_read_b64_tr_b16 v[230:231], v16 offset:5504
    ds_read_b64_tr_b16 v[232:233], v16 offset:3840
    v_mfma_f32_32x32x16_bf16 v[144:159], v[208:211], v[196:199], v[144:159]
    ds_read_b64_tr_b16 v[234:235], v16 offset:5632
    s_waitcnt lgkmcnt(8)
    v_mfma_f32_32x32x16_bf16 v[160:175], v[212:215], v[192:195], v[160:175]
    ds_read_b64_tr_b16 v[236:237], v16 offset:3968
    v_mfma_f32_32x32x16_bf16 v[176:191], v[212:215], v[196:199], v[176:191]
    ds_read_b64_tr_b16 v[238:239], v16 offset:5760
    s_add_u32 s53, s53, 30976
    s_cmp_ge_u32 s53, 154880
    s_cselect_b32 s53, 0, s53
    s_cselect_b32 s96, s97, 30976
    v_add_u32 v14, s96, v14
    v_add_u32 v16, s96, v16
    s_waitcnt lgkmcnt(7)
    v_mfma_f32_32x32x16_bf16 v[64:79], v[224:227], v[216:219], v[64:79]
    ds_read_b128 v[192:195], v14 offset:0
    ds_read_b64_tr_b16 v[200:201], v16 offset:0
    s_waitcnt lgkmcnt(8)
    v_mfma_f32_32x32x16_bf16 v[80:95], v[224:227], v[220:223], v[80:95]
    ds_read_b64_tr_b16 v[202:203], v16 offset:1792
    s_waitcnt lgkmcnt(7)
    v_mfma_f32_32x32x16_bf16 v[96:111], v[228:231], v[216:219], v[96:111]
    ds_read_b128 v[196:199], v14 offset:2048
    v_mfma_f32_32x32x16_bf16 v[112:127], v[228:231], v[220:223], v[112:127]
    ds_read_b64_tr_b16 v[204:205], v16 offset:128
    s_waitcnt lgkmcnt(7)
    v_mfma_f32_32x32x16_bf16 v[128:143], v[232:235], v[216:219], v[128:143]
    ds_read_b64_tr_b16 v[206:207], v16 offset:1920
    ds_read_b64_tr_b16 v[208:209], v16 offset:256
    v_mfma_f32_32x32x16_bf16 v[144:159], v[232:235], v[220:223], v[144:159]
    ds_read_b64_tr_b16 v[210:211], v16 offset:2048
    s_waitcnt lgkmcnt(8)
    v_mfma_f32_32x32x16_bf16 v[160:175], v[236:239], v[216:219], v[160:175]
    ds_read_b64_tr_b16 v[212:213], v16 offset:384
    v_mfma_f32_32x32x16_bf16 v[176:191], v[236:239], v[220:223], v[176:191]
    ds_read_b64_tr_b16 v[214:215], v16 offset:2176
    s_sub_u32 s54, s54, 1
    s_cmp_lg_u32 s54, 0
    s_cbranch_scc1 L_k3_glu_kernel_loop_4
    s_waitcnt vmcnt(8)
    s_barrier
    s_waitcnt lgkmcnt(7)
    v_mfma_f32_32x32x16_bf16 v[64:79], v[200:203], v[192:195], v[64:79]
    ds_read_b128 v[216:219], v14 offset:1024
    ds_read_b64_tr_b16 v[224:225], v16 offset:3584
    s_waitcnt lgkmcnt(8)
    v_mfma_f32_32x32x16_bf16 v[80:95], v[200:203], v[196:199], v[80:95]
    ds_read_b64_tr_b16 v[226:227], v16 offset:5376
    s_waitcnt lgkmcnt(7)
    v_mfma_f32_32x32x16_bf16 v[96:111], v[204:207], v[192:195], v[96:111]
    ds_read_b128 v[220:223], v14 offset:3072
    v_mfma_f32_32x32x16_bf16 v[112:127], v[204:207], v[196:199], v[112:127]
    ds_read_b64_tr_b16 v[228:229], v16 offset:3712
    s_waitcnt lgkmcnt(7)
    v_mfma_f32_32x32x16_bf16 v[128:143], v[208:211], v[192:195], v[128:143]
    ds_read_b64_tr_b16 v[230:231], v16 offset:5504
    ds_read_b64_tr_b16 v[232:233], v16 offset:3840
    v_mfma_f32_32x32x16_bf16 v[144:159], v[208:211], v[196:199], v[144:159]
    ds_read_b64_tr_b16 v[234:235], v16 offset:5632
    s_waitcnt lgkmcnt(8)
    v_mfma_f32_32x32x16_bf16 v[160:175], v[212:215], v[192:195], v[160:175]
    ds_read_b64_tr_b16 v[236:237], v16 offset:3968
    v_mfma_f32_32x32x16_bf16 v[176:191], v[212:215], v[196:199], v[176:191]
    ds_read_b64_tr_b16 v[238:239], v16 offset:5760
    s_add_u32 s53, s53, 30976
    s_cmp_ge_u32 s53, 154880
    s_cselect_b32 s53, 0, s53
    s_cselect_b32 s96, s97, 30976
    v_add_u32 v14, s96, v14
    v_add_u32 v16, s96, v16
    s_waitcnt lgkmcnt(7)
    v_mfma_f32_32x32x16_bf16 v[64:79], v[224:227], v[216:219], v[64:79]
    ds_read_b128 v[192:195], v14 offset:0
    ds_read_b64_tr_b16 v[200:201], v16 offset:0
    s_waitcnt lgkmcnt(8)
    v_mfma_f32_32x32x16_bf16 v[80:95], v[224:227], v[220:223], v[80:95]
    ds_read_b64_tr_b16 v[202:203], v16 offset:1792
    s_waitcnt lgkmcnt(7)
    v_mfma_f32_32x32x16_bf16 v[96:111], v[228:231], v[216:219], v[96:111]
    ds_read_b128 v[196:199], v14 offset:2048
    v_mfma_f32_32x32x16_bf16 v[112:127], v[228:231], v[220:223], v[112:127]
    ds_read_b64_tr_b16 v[204:205], v16 offset:128
    s_waitcnt lgkmcnt(7)
    v_mfma_f32_32x32x16_bf16 v[128:143], v[232:235], v[216:219], v[128:143]
    ds_read_b64_tr_b16 v[206:207], v16 offset:1920
    ds_read_b64_tr_b16 v[208:209], v16 offset:256
    v_mfma_f32_32x32x16_bf16 v[144:159], v[232:235], v[220:223], v[144:159]
    ds_read_b64_tr_b16 v[210:211], v16 offset:2048
    s_waitcnt lgkmcnt(8)
    v_mfma_f32_32x32x16_bf16 v[160:175], v[236:239], v[216:219], v[160:175]
    ds_read_b64_tr_b16 v[212:213], v16 offset:384
    v_mfma_f32_32x32x16_bf16 v[176:191], v[236:239], v[220:223], v[176:191]
    ds_read_b64_tr_b16 v[214:215], v16 offset:2176
    s_lshl_b32 s30, s26, 6
    s_add_u32 s30, s30, s24
    v_and_b32 v3, 31, v2
    v_add_u32 v3, s30, v3
    v_lshlrev_b32 v4, 3, v3
    v_lshrrev_b32 v5, 5, v2
    v_lshl_add_u32 v4, v5, 16, v4
    s_mov_b32 s31, 0
    buffer_load_dwordx2 v[24:25], v4, s[64:67], s31 offen
    buffer_load_dwordx2 v[32:33], v4, s[64:67], s31 offen offset:256
    s_add_u32 s31, s31, 16384
    buffer_load_dwordx2 v[26:27], v4, s[64:67], s31 offen
    buffer_load_dwordx2 v[34:35], v4, s[64:67], s31 offen offset:256
    s_add_u32 s31, s31, 16384
    buffer_load_dwordx2 v[28:29], v4, s[64:67], s31 offen
    buffer_load_dwordx2 v[36:37], v4, s[64:67], s31 offen offset:256
    s_add_u32 s31, s31, 16384
    buffer_load_dwordx2 v[30:31], v4, s[64:67], s31 offen
    buffer_load_dwordx2 v[38:39], v4, s[64:67], s31 offen offset:256
    s_add_u32 s31, s31, 16384
    v_cmp_gt_u32 vcc, 28, v2
    v_subrev_u32 v6, 28, v2
    s_nop 1
    v_cndmask_b32 v6, v6, v2, vcc
    v_lshlrev_b32 v6, 4, v6
    v_mov_b32 v7, 14336
    v_mov_b32 v8, 0
    v_cndmask_b32 v7, v7, v8, vcc
    v_add_u32 v6, v6, v7
    s_mul_i32 s31, s22, 448
    v_add_u32 v6, s31, v6
    s_mov_b32 s31, 0
    buffer_load_dwordx4 v[40:43], v6, s[68:71], s31 offen
    s_add_u32 s31, s31, 28672
    buffer_load_dwordx4 v[44:47], v6, s[68:71], s31 offen
    s_add_u32 s31, s31, 28672
    buffer_load_dwordx4 v[48:51], v6, s[68:71], s31 offen
    s_add_u32 s31, s31, 28672
    buffer_load_dwordx4 v[52:55], v6, s[68:71], s31 offen
    s_add_u32 s31, s31, 28672
    s_waitcnt vmcnt(16)
    s_barrier
    s_waitcnt lgkmcnt(7)
    v_mfma_f32_32x32x16_bf16 v[64:79], v[200:203], v[192:195], v[64:79]
    ds_read_b128 v[216:219], v14 offset:1024
    ds_read_b64_tr_b16 v[224:225], v16 offset:3584
    s_waitcnt lgkmcnt(8)
    v_mfma_f32_32x32x16_bf16 v[80:95], v[200:203], v[196:199], v[80:95]
    ds_read_b64_tr_b16 v[226:227], v16 offset:5376
    s_waitcnt lgkmcnt(7)
    v_mfma_f32_32x32x16_bf16 v[96:111], v[204:207], v[192:195], v[96:111]
    ds_read_b128 v[220:223], v14 offset:3072
    v_mfma_f32_32x32x16_bf16 v[112:127], v[204:207], v[196:199], v[112:127]
    ds_read_b64_tr_b16 v[228:229], v16 offset:3712
    s_waitcnt lgkmcnt(7)
    v_mfma_f32_32x32x16_bf16 v[128:143], v[208:211], v[192:195], v[128:143]
    ds_read_b64_tr_b16 v[230:231], v16 offset:5504
    ds_read_b64_tr_b16 v[232:233], v16 offset:3840
    v_mfma_f32_32x32x16_bf16 v[144:159], v[208:211], v[196:199], v[144:159]
    ds_read_b64_tr_b16 v[234:235], v16 offset:5632
    s_waitcnt lgkmcnt(8)
    v_mfma_f32_32x32x16_bf16 v[160:175], v[212:215], v[192:195], v[160:175]
    ds_read_b64_tr_b16 v[236:237], v16 offset:3968
    v_mfma_f32_32x32x16_bf16 v[176:191], v[212:215], v[196:199], v[176:191]
    ds_read_b64_tr_b16 v[238:239], v16 offset:5760
    s_add_u32 s53, s53, 30976
    s_cmp_ge_u32 s53, 154880
    s_cselect_b32 s53, 0, s53
    s_cselect_b32 s96, s97, 30976
    v_add_u32 v14, s96, v14
    v_add_u32 v16, s96, v16
    s_waitcnt lgkmcnt(7)
    v_mfma_f32_32x32x16_bf16 v[64:79], v[224:227], v[216:219], v[64:79]
    ds_read_b128 v[192:195], v14 offset:0
    ds_read_b64_tr_b16 v[200:201], v16 offset:0
    s_waitcnt lgkmcnt(8)
    v_mfma_f32_32x32x16_bf16 v[80:95], v[224:227], v[220:223], v[80:95]
    ds_read_b64_tr_b16 v[202:203], v16 offset:1792
    s_waitcnt lgkmcnt(7)
    v_mfma_f32_32x32x16_bf16 v[96:111], v[228:231], v[216:219], v[96:111]
    ds_read_b128 v[196:199], v14 offset:2048
    v_mfma_f32_32x32x16_bf16 v[112:127], v[228:231], v[220:223], v[112:127]
    ds_read_b64_tr_b16 v[204:205], v16 offset:128
    s_waitcnt lgkmcnt(7)
    v_mfma_f32_32x32x16_bf16 v[128:143], v[232:235], v[216:219], v[128:143]
    ds_read_b64_tr_b16 v[206:207], v16 offset:1920
    ds_read_b64_tr_b16 v[208:209], v16 offset:256
    v_mfma_f32_32x32x16_bf16 v[144:159], v[232:235], v[220:223], v[144:159]
    ds_read_b64_tr_b16 v[210:211], v16 offset:2048
    s_waitcnt lgkmcnt(8)
    v_mfma_f32_32x32x16_bf16 v[160:175], v[236:239], v[216:219], v[160:175]
    ds_read_b64_tr_b16 v[212:213], v16 offset:384
    v_mfma_f32_32x32x16_bf16 v[176:191], v[236:239], v[220:223], v[176:191]
    ds_read_b64_tr_b16 v[214:215], v16 offset:2176
    s_waitcnt vmcnt(12)
    s_barrier
    s_waitcnt lgkmcnt(7)
    v_mfma_f32_32x32x16_bf16 v[64:79], v[200:203], v[192:195], v[64:79]
    ds_read_b128 v[216:219], v14 offset:1024
    ds_read_b64_tr_b16 v[224:225], v16 offset:3584
    s_waitcnt lgkmcnt(8)
    v_mfma_f32_32x32x16_bf16 v[80:95], v[200:203], v[196:199], v[80:95]
    ds_read_b64_tr_b16 v[226:227], v16 offset:5376
    s_waitcnt lgkmcnt(7)
    v_mfma_f32_32x32x16_bf16 v[96:111], v[204:207], v[192:195], v[96:111]
    ds_read_b128 v[220:223], v14 offset:3072
    v_mfma_f32_32x32x16_bf16 v[112:127], v[204:207], v[196:199], v[112:127]
    ds_read_b64_tr_b16 v[228:229], v16 offset:3712
    s_waitcnt lgkmcnt(7)
    v_mfma_f32_32x32x16_bf16 v[128:143], v[208:211], v[192:195], v[128:143]
    ds_read_b64_tr_b16 v[230:231], v16 offset:5504
    ds_read_b64_tr_b16 v[232:233], v16 offset:3840
    v_mfma_f32_32x32x16_bf16 v[144:159], v[208:211], v[196:199], v[144:159]
    ds_read_b64_tr_b16 v[234:235], v16 offset:5632
    s_waitcnt lgkmcnt(8)
    v_mfma_f32_32x32x16_bf16 v[160:175], v[212:215], v[192:195], v[160:175]
    ds_read_b64_tr_b16 v[236:237], v16 offset:3968
    v_mfma_f32_32x32x16_bf16 v[176:191], v[212:215], v[196:199], v[176:191]
    ds_read_b64_tr_b16 v[238:239], v16 offset:5760
    s_add_u32 s53, s53, 30976
    s_cmp_ge_u32 s53, 154880
    s_cselect_b32 s53, 0, s53
    s_cselect_b32 s96, s97, 30976
    v_add_u32 v14, s96, v14
    v_add_u32 v16, s96, v16
    s_waitcnt lgkmcnt(7)
    v_mfma_f32_32x32x16_bf16 v[64:79], v[224:227], v[216:219], v[64:79]
    ds_read_b128 v[192:195], v14 offset:0
    ds_read_b64_tr_b16 v[200:201], v16 offset:0
    s_waitcnt lgkmcnt(8)
    v_mfma_f32_32x32x16_bf16 v[80:95], v[224:227], v[220:223], v[80:95]
    ds_read_b64_tr_b16 v[202:203], v16 offset:1792
    s_waitcnt lgkmcnt(7)
    v_mfma_f32_32x32x16_bf16 v[96:111], v[228:231], v[216:219], v[96:111]
    ds_read_b128 v[196:199], v14 offset:2048
    v_mfma_f32_32x32x16_bf16 v[112:127], v[228:231], v[220:223], v[112:127]
    ds_read_b64_tr_b16 v[204:205], v16 offset:128
    s_waitcnt lgkmcnt(7)
    v_mfma_f32_32x32x16_bf16 v[128:143], v[232:235], v[216:219], v[128:143]
    ds_read_b64_tr_b16 v[206:207], v16 offset:1920
    ds_read_b64_tr_b16 v[208:209], v16 offset:256
    v_mfma_f32_32x32x16_bf16 v[144:159], v[232:235], v[220:223], v[144:159]
    ds_read_b64_tr_b16 v[210:211], v16 offset:2048
    s_waitcnt lgkmcnt(8)
    v_mfma_f32_32x32x16_bf16 v[160:175], v[236:239], v[216:219], v[160:175]
    ds_read_b64_tr_b16 v[212:213], v16 offset:384
    v_mfma_f32_32x32x16_bf16 v[176:191], v[236:239], v[220:223], v[176:191]
    ds_read_b64_tr_b16 v[214:215], v16 offset:2176
    s_waitcnt vmcnt(12)
    s_barrier
    s_waitcnt lgkmcnt(7)
    v_mfma_f32_32x32x16_bf16 v[64:79], v[200:203], v[192:195], v[64:79]
    ds_read_b128 v[216:219], v14 offset:1024
    ds_read_b64_tr_b16 v[224:225], v16 offset:3584
    s_waitcnt lgkmcnt(8)
    v_mfma_f32_32x32x16_bf16 v[80:95], v[200:203], v[196:199], v[80:95]
    ds_read_b64_tr_b16 v[226:227], v16 offset:5376
    s_waitcnt lgkmcnt(7)
    v_mfma_f32_32x32x16_bf16 v[96:111], v[204:207], v[192:195], v[96:111]
    ds_read_b128 v[220:223], v14 offset:3072
    v_mfma_f32_32x32x16_bf16 v[112:127], v[204:207], v[196:199], v[112:127]
    ds_read_b64_tr_b16 v[228:229], v16 offset:3712
    s_waitcnt lgkmcnt(7)
    v_mfma_f32_32x32x16_bf16 v[128:143], v[208:211], v[192:195], v[128:143]
    ds_read_b64_tr_b16 v[230:231], v16 offset:5504
    ds_read_b64_tr_b16 v[232:233], v16 offset:3840
    v_mfma_f32_32x32x16_bf16 v[144:159], v[208:211], v[196:199], v[144:159]
    ds_read_b64_tr_b16 v[234:235], v16 offset:5632
    s_waitcnt lgkmcnt(8)
    v_mfma_f32_32x32x16_bf16 v[160:175], v[212:215], v[192:195], v[160:175]
    ds_read_b64_tr_b16 v[236:237], v16 offset:3968
    v_mfma_f32_32x32x16_bf16 v[176:191], v[212:215], v[196:199], v[176:191]
    ds_read_b64_tr_b16 v[238:239], v16 offset:5760
    s_waitcnt lgkmcnt(7)
    v_mfma_f32_32x32x16_bf16 v[64:79], v[224:227], v[216:219], v[64:79]
    s_waitcnt lgkmcnt(6)
    v_mfma_f32_32x32x16_bf16 v[80:95], v[224:227], v[220:223], v[80:95]
    s_waitcnt lgkmcnt(4)
    v_mfma_f32_32x32x16_bf16 v[96:111], v[228:231], v[216:219], v[96:111]
    v_mfma_f32_32x32x16_bf16 v[112:127], v[228:231], v[220:223], v[112:127]
    s_waitcnt lgkmcnt(2)
    v_mfma_f32_32x32x16_bf16 v[128:143], v[232:235], v[216:219], v[128:143]
    v_mfma_f32_32x32x16_bf16 v[144:159], v[232:235], v[220:223], v[144:159]
    s_waitcnt lgkmcnt(0)
    v_mfma_f32_32x32x16_bf16 v[160:175], v[236:239], v[216:219], v[160:175]
    v_mfma_f32_32x32x16_bf16 v[176:191], v[236:239], v[220:223], v[176:191]
    s_waitcnt vmcnt(0)
    v_pk_add_f32 v[40:41], v[40:41], v[44:45]
    v_pk_add_f32 v[48:49], v[48:49], v[52:53]
    v_pk_add_f32 v[40:41], v[40:41], v[48:49]
    v_pk_add_f32 v[42:43], v[42:43], v[46:47]
    v_pk_add_f32 v[50:51], v[50:51], v[54:55]
    v_pk_add_f32 v[42:43], v[42:43], v[50:51]
    v_add_u32 v6, 154880, v9
    v_cmp_gt_u32 vcc, 56, v2
    s_and_saveexec_b64 s[36:37], vcc
    ds_write_b128 v6, v[40:43]
    s_mov_b64 exec, s[36:37]
    v_pk_add_f32 v[24:25], v[24:25], v[26:27]
    v_pk_add_f32 v[28:29], v[28:29], v[30:31]
    v_pk_add_f32 v[24:25], v[24:25], v[28:29]
    v_mov_b32 v26, v24
    v_mov_b32 v27, v25
    v_pk_add_f32 v[32:33], v[32:33], v[34:35]
    v_pk_add_f32 v[36:37], v[36:37], v[38:39]
    v_pk_add_f32 v[32:33], v[32:33], v[36:37]
    v_mov_b32 v34, v32
    v_mov_b32 v35, v33
    s_nop 1
    v_permlane32_swap_b32 v24, v26
    v_permlane32_swap_b32 v25, v27
    v_permlane32_swap_b32 v32, v34
    v_permlane32_swap_b32 v33, v35
    s_nop 1
    v_pk_add_f32 v[24:25], v[24:25], v[26:27]
    v_pk_add_f32 v[32:33], v[32:33], v[34:35]
    s_waitcnt lgkmcnt(0)
    s_barrier
    v_lshrrev_b32 v6, 5, v2
    v_lshlrev_b32 v5, 4, v6
    v_add_u32 v5, 154880, v5
    ds_read_b128 v[192:195], v5 offset:0
    ds_read_b128 v[200:203], v5 offset:448
    ds_read_b128 v[196:199], v5 offset:32
    ds_read_b128 v[204:207], v5 offset:480
    ds_read_b128 v[208:211], v5 offset:64
    ds_read_b128 v[216:219], v5 offset:512
    ds_read_b128 v[212:215], v5 offset:96
    ds_read_b128 v[220:223], v5 offset:544
    v_mul_f32 v24, 0x3a800000, v24
    v_mul_f32 v25, 0x3a800000, v25
    v_fma_f32 v25, -v24, v24, v25
    v_max_f32 v25, 0, v25
    v_cvt_pk_bf16_f32 v24, v24, v24
    v_lshlrev_b32 v24, 16, v24
    v_cvt_pk_bf16_f32 v25, v25, v25
    v_lshlrev_b32 v25, 16, v25
    v_add_f32 v25, 0x3727c5ac, v25
    v_cvt_pk_bf16_f32 v25, v25, v25
    v_lshlrev_b32 v25, 16, v25
    v_sqrt_f32 v25, v25
    s_nop 0
    v_cvt_pk_bf16_f32 v25, v25, v25
    v_lshlrev_b32 v25, 16, v25
    v_rcp_f32 v28, v25
    s_nop 0
    v_mov_b32 v29, v28
    v_mul_f32 v24, v24, v28
    v_sub_f32 v30, 0, v24
    v_mov_b32 v31, v30
    v_mul_f32 v32, 0x3a800000, v32
    v_mul_f32 v33, 0x3a800000, v33
    v_fma_f32 v33, -v32, v32, v33
    v_max_f32 v33, 0, v33
    v_cvt_pk_bf16_f32 v32, v32, v32
    v_lshlrev_b32 v32, 16, v32
    v_cvt_pk_bf16_f32 v33, v33, v33
    v_lshlrev_b32 v33, 16, v33
    v_add_f32 v33, 0x3727c5ac, v33
    v_cvt_pk_bf16_f32 v33, v33, v33
    v_lshlrev_b32 v33, 16, v33
    v_sqrt_f32 v33, v33
    s_nop 0
    v_cvt_pk_bf16_f32 v33, v33, v33
    v_lshlrev_b32 v33, 16, v33
    v_rcp_f32 v36, v33
    s_nop 0
    v_mov_b32 v37, v36
    v_mul_f32 v32, v32, v36
    v_sub_f32 v38, 0, v32
    v_mov_b32 v39, v38
    s_lshl_b32 s31, s23, 3
    s_lshl_b32 s30, s26, 1
    s_add_u32 s31, s31, s30
    s_mul_i32 s31, s31, 224
    s_mul_i32 s30, s22, 7
    s_add_u32 s31, s31, s30
    s_add_u32 s31, s31, 0
    s_lshl_b32 s31, s31, 10
    v_add_u32 v56, s31, v9
    v_add_u32 v57, 229376, v56
    v_mov_b32 v60, 0xc0135761
    v_mov_b32 v61, 0xc0135761
    v_mov_b32 v62, 0xbdd2d3e8
    v_mov_b32 v63, 0xbdd2d3e8
    v_mov_b32 v58, 1.0
    v_mov_b32 v59, 1.0
    s_waitcnt lgkmcnt(4)
    v_pk_mul_f32 v[224:225], v[192:193], v[30:31]
    v_pk_mul_f32 v[226:227], v[194:195], v[30:31]
    v_pk_mul_f32 v[228:229], v[196:197], v[30:31]
    v_pk_mul_f32 v[230:231], v[198:199], v[30:31]
    v_pk_mul_f32 v[232:233], v[200:201], v[30:31]
    v_pk_mul_f32 v[234:235], v[202:203], v[30:31]
    v_pk_mul_f32 v[236:237], v[204:205], v[30:31]
    v_pk_mul_f32 v[238:239], v[206:207], v[30:31]
    v_pk_fma_f32 v[64:65], v[64:65], v[28:29], v[224:225]
    v_pk_fma_f32 v[66:67], v[66:67], v[28:29], v[226:227]
    v_pk_fma_f32 v[68:69], v[68:69], v[28:29], v[228:229]
    v_pk_fma_f32 v[70:71], v[70:71], v[28:29], v[230:231]
    v_pk_fma_f32 v[72:73], v[72:73], v[28:29], v[232:233]
    v_pk_fma_f32 v[74:75], v[74:75], v[28:29], v[234:235]
    v_pk_fma_f32 v[76:77], v[76:77], v[28:29], v[236:237]
    v_pk_fma_f32 v[78:79], v[78:79], v[28:29], v[238:239]
    v_pk_mul_f32 v[224:225], v[64:65], v[64:65]
    v_pk_mul_f32 v[226:227], v[66:67], v[66:67]
    v_pk_mul_f32 v[228:229], v[68:69], v[68:69]
    v_pk_mul_f32 v[230:231], v[70:71], v[70:71]
    v_pk_fma_f32 v[224:225], v[224:225], v[62:63], v[60:61]
    v_pk_fma_f32 v[226:227], v[226:227], v[62:63], v[60:61]
    v_pk_fma_f32 v[228:229], v[228:229], v[62:63], v[60:61]
    v_pk_fma_f32 v[230:231], v[230:231], v[62:63], v[60:61]
    v_pk_mul_f32 v[224:225], v[224:225], v[64:65]
    v_pk_mul_f32 v[226:227], v[226:227], v[66:67]
    v_pk_mul_f32 v[228:229], v[228:229], v[68:69]
    v_pk_mul_f32 v[230:231], v[230:231], v[70:71]
    v_exp_f32 v224, v224
    v_exp_f32 v225, v225
    v_exp_f32 v226, v226
    v_exp_f32 v227, v227
    v_exp_f32 v228, v228
    v_exp_f32 v229, v229
    v_exp_f32 v230, v230
    v_exp_f32 v231, v231
    v_pk_mul_f32 v[64:65], v[64:65], v[72:73]
    v_pk_mul_f32 v[66:67], v[66:67], v[74:75]
    v_pk_mul_f32 v[68:69], v[68:69], v[76:77]
    v_pk_mul_f32 v[70:71], v[70:71], v[78:79]
    v_pk_add_f32 v[224:225], v[224:225], v[58:59]
    v_pk_add_f32 v[226:227], v[226:227], v[58:59]
    v_pk_add_f32 v[228:229], v[228:229], v[58:59]
    v_pk_add_f32 v[230:231], v[230:231], v[58:59]
    v_rcp_f32 v224, v224
    v_rcp_f32 v225, v225
    v_rcp_f32 v226, v226
    v_rcp_f32 v227, v227
    v_rcp_f32 v228, v228
    v_rcp_f32 v229, v229
    v_rcp_f32 v230, v230
    v_rcp_f32 v231, v231
    s_nop 0
    v_pk_mul_f32 v[64:65], v[64:65], v[224:225]
    v_pk_mul_f32 v[66:67], v[66:67], v[226:227]
    v_pk_mul_f32 v[68:69], v[68:69], v[228:229]
    v_pk_mul_f32 v[70:71], v[70:71], v[230:231]
    v_cvt_pk_bf16_f32 v44, v64, v65
    v_cvt_pk_bf16_f32 v45, v66, v67
    v_cvt_pk_bf16_f32 v46, v68, v69
    v_cvt_pk_bf16_f32 v47, v70, v71
    buffer_store_dwordx4 v[44:47], v56, s[76:79], 0 offen offset:0 sc1
    v_pk_mul_f32 v[224:225], v[192:193], v[38:39]
    v_pk_mul_f32 v[226:227], v[194:195], v[38:39]
    v_pk_mul_f32 v[228:229], v[196:197], v[38:39]
    v_pk_mul_f32 v[230:231], v[198:199], v[38:39]
    v_pk_mul_f32 v[232:233], v[200:201], v[38:39]
    v_pk_mul_f32 v[234:235], v[202:203], v[38:39]
    v_pk_mul_f32 v[236:237], v[204:205], v[38:39]
    v_pk_mul_f32 v[238:239], v[206:207], v[38:39]
    v_pk_fma_f32 v[80:81], v[80:81], v[36:37], v[224:225]
    v_pk_fma_f32 v[82:83], v[82:83], v[36:37], v[226:227]
    v_pk_fma_f32 v[84:85], v[84:85], v[36:37], v[228:229]
    v_pk_fma_f32 v[86:87], v[86:87], v[36:37], v[230:231]
    v_pk_fma_f32 v[88:89], v[88:89], v[36:37], v[232:233]
    v_pk_fma_f32 v[90:91], v[90:91], v[36:37], v[234:235]
    v_pk_fma_f32 v[92:93], v[92:93], v[36:37], v[236:237]
    v_pk_fma_f32 v[94:95], v[94:95], v[36:37], v[238:239]
    ds_read_b128 v[192:195], v5 offset:128
    ds_read_b128 v[200:203], v5 offset:576
    ds_read_b128 v[196:199], v5 offset:160
    ds_read_b128 v[204:207], v5 offset:608
    v_pk_mul_f32 v[224:225], v[80:81], v[80:81]
    v_pk_mul_f32 v[226:227], v[82:83], v[82:83]
    v_pk_mul_f32 v[228:229], v[84:85], v[84:85]
    v_pk_mul_f32 v[230:231], v[86:87], v[86:87]
    v_pk_fma_f32 v[224:225], v[224:225], v[62:63], v[60:61]
    v_pk_fma_f32 v[226:227], v[226:227], v[62:63], v[60:61]
    v_pk_fma_f32 v[228:229], v[228:229], v[62:63], v[60:61]
    v_pk_fma_f32 v[230:231], v[230:231], v[62:63], v[60:61]
    v_pk_mul_f32 v[224:225], v[224:225], v[80:81]
    v_pk_mul_f32 v[226:227], v[226:227], v[82:83]
    v_pk_mul_f32 v[228:229], v[228:229], v[84:85]
    v_pk_mul_f32 v[230:231], v[230:231], v[86:87]
    v_exp_f32 v224, v224
    v_exp_f32 v225, v225
    v_exp_f32 v226, v226
    v_exp_f32 v227, v227
    v_exp_f32 v228, v228
    v_exp_f32 v229, v229
    v_exp_f32 v230, v230
    v_exp_f32 v231, v231
    v_pk_mul_f32 v[80:81], v[80:81], v[88:89]
    v_pk_mul_f32 v[82:83], v[82:83], v[90:91]
    v_pk_mul_f32 v[84:85], v[84:85], v[92:93]
    v_pk_mul_f32 v[86:87], v[86:87], v[94:95]
    v_pk_add_f32 v[224:225], v[224:225], v[58:59]
    v_pk_add_f32 v[226:227], v[226:227], v[58:59]
    v_pk_add_f32 v[228:229], v[228:229], v[58:59]
    v_pk_add_f32 v[230:231], v[230:231], v[58:59]
    v_rcp_f32 v224, v224
    v_rcp_f32 v225, v225
    v_rcp_f32 v226, v226
    v_rcp_f32 v227, v227
    v_rcp_f32 v228, v228
    v_rcp_f32 v229, v229
    v_rcp_f32 v230, v230
    v_rcp_f32 v231, v231
    s_nop 0
    v_pk_mul_f32 v[80:81], v[80:81], v[224:225]
    v_pk_mul_f32 v[82:83], v[82:83], v[226:227]
    v_pk_mul_f32 v[84:85], v[84:85], v[228:229]
    v_pk_mul_f32 v[86:87], v[86:87], v[230:231]
    v_cvt_pk_bf16_f32 v48, v80, v81
    v_cvt_pk_bf16_f32 v49, v82, v83
    v_cvt_pk_bf16_f32 v50, v84, v85
    v_cvt_pk_bf16_f32 v51, v86, v87
    buffer_store_dwordx4 v[48:51], v57, s[76:79], 0 offen offset:0 sc1
    s_waitcnt lgkmcnt(4)
    v_pk_mul_f32 v[224:225], v[208:209], v[30:31]
    v_pk_mul_f32 v[226:227], v[210:211], v[30:31]
    v_pk_mul_f32 v[228:229], v[212:213], v[30:31]
    v_pk_mul_f32 v[230:231], v[214:215], v[30:31]
    v_pk_mul_f32 v[232:233], v[216:217], v[30:31]
    v_pk_mul_f32 v[234:235], v[218:219], v[30:31]
    v_pk_mul_f32 v[236:237], v[220:221], v[30:31]
    v_pk_mul_f32 v[238:239], v[222:223], v[30:31]
    v_pk_fma_f32 v[96:97], v[96:97], v[28:29], v[224:225]
    v_pk_fma_f32 v[98:99], v[98:99], v[28:29], v[226:227]
    v_pk_fma_f32 v[100:101], v[100:101], v[28:29], v[228:229]
    v_pk_fma_f32 v[102:103], v[102:103], v[28:29], v[230:231]
    v_pk_fma_f32 v[104:105], v[104:105], v[28:29], v[232:233]
    v_pk_fma_f32 v[106:107], v[106:107], v[28:29], v[234:235]
    v_pk_fma_f32 v[108:109], v[108:109], v[28:29], v[236:237]
    v_pk_fma_f32 v[110:111], v[110:111], v[28:29], v[238:239]
    v_pk_mul_f32 v[224:225], v[96:97], v[96:97]
    v_pk_mul_f32 v[226:227], v[98:99], v[98:99]
    v_pk_mul_f32 v[228:229], v[100:101], v[100:101]
    v_pk_mul_f32 v[230:231], v[102:103], v[102:103]
    v_pk_fma_f32 v[224:225], v[224:225], v[62:63], v[60:61]
    v_pk_fma_f32 v[226:227], v[226:227], v[62:63], v[60:61]
    v_pk_fma_f32 v[228:229], v[228:229], v[62:63], v[60:61]
    v_pk_fma_f32 v[230:231], v[230:231], v[62:63], v[60:61]
    v_pk_mul_f32 v[224:225], v[224:225], v[96:97]
    v_pk_mul_f32 v[226:227], v[226:227], v[98:99]
    v_pk_mul_f32 v[228:229], v[228:229], v[100:101]
    v_pk_mul_f32 v[230:231], v[230:231], v[102:103]
    v_exp_f32 v224, v224
    v_exp_f32 v225, v225
    v_exp_f32 v226, v226
    v_exp_f32 v227, v227
    v_exp_f32 v228, v228
    v_exp_f32 v229, v229
    v_exp_f32 v230, v230
    v_exp_f32 v231, v231
    v_pk_mul_f32 v[96:97], v[96:97], v[104:105]
    v_pk_mul_f32 v[98:99], v[98:99], v[106:107]
    v_pk_mul_f32 v[100:101], v[100:101], v[108:109]
    v_pk_mul_f32 v[102:103], v[102:103], v[110:111]
    v_pk_add_f32 v[224:225], v[224:225], v[58:59]
    v_pk_add_f32 v[226:227], v[226:227], v[58:59]
    v_pk_add_f32 v[228:229], v[228:229], v[58:59]
    v_pk_add_f32 v[230:231], v[230:231], v[58:59]
    v_rcp_f32 v224, v224
    v_rcp_f32 v225, v225
    v_rcp_f32 v226, v226
    v_rcp_f32 v227, v227
    v_rcp_f32 v228, v228
    v_rcp_f32 v229, v229
    v_rcp_f32 v230, v230
    v_rcp_f32 v231, v231
    s_nop 0
    v_pk_mul_f32 v[96:97], v[96:97], v[224:225]
    v_pk_mul_f32 v[98:99], v[98:99], v[226:227]
    v_pk_mul_f32 v[100:101], v[100:101], v[228:229]
    v_pk_mul_f32 v[102:103], v[102:103], v[230:231]
    v_cvt_pk_bf16_f32 v44, v96, v97
    v_cvt_pk_bf16_f32 v45, v98, v99
    v_cvt_pk_bf16_f32 v46, v100, v101
    v_cvt_pk_bf16_f32 v47, v102, v103
    buffer_store_dwordx4 v[44:47], v56, s[76:79], 0 offen offset:1024 sc1
    v_pk_mul_f32 v[224:225], v[208:209], v[38:39]
    v_pk_mul_f32 v[226:227], v[210:211], v[38:39]
    v_pk_mul_f32 v[228:229], v[212:213], v[38:39]
    v_pk_mul_f32 v[230:231], v[214:215], v[38:39]
    v_pk_mul_f32 v[232:233], v[216:217], v[38:39]
    v_pk_mul_f32 v[234:235], v[218:219], v[38:39]
    v_pk_mul_f32 v[236:237], v[220:221], v[38:39]
    v_pk_mul_f32 v[238:239], v[222:223], v[38:39]
    v_pk_fma_f32 v[112:113], v[112:113], v[36:37], v[224:225]
    v_pk_fma_f32 v[114:115], v[114:115], v[36:37], v[226:227]
    v_pk_fma_f32 v[116:117], v[116:117], v[36:37], v[228:229]
    v_pk_fma_f32 v[118:119], v[118:119], v[36:37], v[230:231]
    v_pk_fma_f32 v[120:121], v[120:121], v[36:37], v[232:233]
    v_pk_fma_f32 v[122:123], v[122:123], v[36:37], v[234:235]
    v_pk_fma_f32 v[124:125], v[124:125], v[36:37], v[236:237]
    v_pk_fma_f32 v[126:127], v[126:127], v[36:37], v[238:239]
    ds_read_b128 v[208:211], v5 offset:192
    ds_read_b128 v[216:219], v5 offset:640
    ds_read_b128 v[212:215], v5 offset:224
    ds_read_b128 v[220:223], v5 offset:672
    v_pk_mul_f32 v[224:225], v[112:113], v[112:113]
    v_pk_mul_f32 v[226:227], v[114:115], v[114:115]
    v_pk_mul_f32 v[228:229], v[116:117], v[116:117]
    v_pk_mul_f32 v[230:231], v[118:119], v[118:119]
    v_pk_fma_f32 v[224:225], v[224:225], v[62:63], v[60:61]
    v_pk_fma_f32 v[226:227], v[226:227], v[62:63], v[60:61]
    v_pk_fma_f32 v[228:229], v[228:229], v[62:63], v[60:61]
    v_pk_fma_f32 v[230:231], v[230:231], v[62:63], v[60:61]
    v_pk_mul_f32 v[224:225], v[224:225], v[112:113]
    v_pk_mul_f32 v[226:227], v[226:227], v[114:115]
    v_pk_mul_f32 v[228:229], v[228:229], v[116:117]
    v_pk_mul_f32 v[230:231], v[230:231], v[118:119]
    v_exp_f32 v224, v224
    v_exp_f32 v225, v225
    v_exp_f32 v226, v226
    v_exp_f32 v227, v227
    v_exp_f32 v228, v228
    v_exp_f32 v229, v229
    v_exp_f32 v230, v230
    v_exp_f32 v231, v231
    v_pk_mul_f32 v[112:113], v[112:113], v[120:121]
    v_pk_mul_f32 v[114:115], v[114:115], v[122:123]
    v_pk_mul_f32 v[116:117], v[116:117], v[124:125]
    v_pk_mul_f32 v[118:119], v[118:119], v[126:127]
    v_pk_add_f32 v[224:225], v[224:225], v[58:59]
    v_pk_add_f32 v[226:227], v[226:227], v[58:59]
    v_pk_add_f32 v[228:229], v[228:229], v[58:59]
    v_pk_add_f32 v[230:231], v[230:231], v[58:59]
    v_rcp_f32 v224, v224
    v_rcp_f32 v225, v225
    v_rcp_f32 v226, v226
    v_rcp_f32 v227, v227
    v_rcp_f32 v228, v228
    v_rcp_f32 v229, v229
    v_rcp_f32 v230, v230
    v_rcp_f32 v231, v231
    s_nop 0
    v_pk_mul_f32 v[112:113], v[112:113], v[224:225]
    v_pk_mul_f32 v[114:115], v[114:115], v[226:227]
    v_pk_mul_f32 v[116:117], v[116:117], v[228:229]
    v_pk_mul_f32 v[118:119], v[118:119], v[230:231]
    v_cvt_pk_bf16_f32 v48, v112, v113
    v_cvt_pk_bf16_f32 v49, v114, v115
    v_cvt_pk_bf16_f32 v50, v116, v117
    v_cvt_pk_bf16_f32 v51, v118, v119
    buffer_store_dwordx4 v[48:51], v57, s[76:79], 0 offen offset:1024 sc1
    s_waitcnt lgkmcnt(4)
    v_pk_mul_f32 v[224:225], v[192:193], v[30:31]
    v_pk_mul_f32 v[226:227], v[194:195], v[30:31]
    v_pk_mul_f32 v[228:229], v[196:197], v[30:31]
    v_pk_mul_f32 v[230:231], v[198:199], v[30:31]
    v_pk_mul_f32 v[232:233], v[200:201], v[30:31]
    v_pk_mul_f32 v[234:235], v[202:203], v[30:31]
    v_pk_mul_f32 v[236:237], v[204:205], v[30:31]
    v_pk_mul_f32 v[238:239], v[206:207], v[30:31]
    v_pk_fma_f32 v[128:129], v[128:129], v[28:29], v[224:225]
    v_pk_fma_f32 v[130:131], v[130:131], v[28:29], v[226:227]
    v_pk_fma_f32 v[132:133], v[132:133], v[28:29], v[228:229]
    v_pk_fma_f32 v[134:135], v[134:135], v[28:29], v[230:231]
    v_pk_fma_f32 v[136:137], v[136:137], v[28:29], v[232:233]
    v_pk_fma_f32 v[138:139], v[138:139], v[28:29], v[234:235]
    v_pk_fma_f32 v[140:141], v[140:141], v[28:29], v[236:237]
    v_pk_fma_f32 v[142:143], v[142:143], v[28:29], v[238:239]
    v_pk_mul_f32 v[224:225], v[128:129], v[128:129]
    v_pk_mul_f32 v[226:227], v[130:131], v[130:131]
    v_pk_mul_f32 v[228:229], v[132:133], v[132:133]
    v_pk_mul_f32 v[230:231], v[134:135], v[134:135]
    v_pk_fma_f32 v[224:225], v[224:225], v[62:63], v[60:61]
    v_pk_fma_f32 v[226:227], v[226:227], v[62:63], v[60:61]
    v_pk_fma_f32 v[228:229], v[228:229], v[62:63], v[60:61]
    v_pk_fma_f32 v[230:231], v[230:231], v[62:63], v[60:61]
    v_pk_mul_f32 v[224:225], v[224:225], v[128:129]
    v_pk_mul_f32 v[226:227], v[226:227], v[130:131]
    v_pk_mul_f32 v[228:229], v[228:229], v[132:133]
    v_pk_mul_f32 v[230:231], v[230:231], v[134:135]
    v_exp_f32 v224, v224
    v_exp_f32 v225, v225
    v_exp_f32 v226, v226
    v_exp_f32 v227, v227
    v_exp_f32 v228, v228
    v_exp_f32 v229, v229
    v_exp_f32 v230, v230
    v_exp_f32 v231, v231
    v_pk_mul_f32 v[128:129], v[128:129], v[136:137]
    v_pk_mul_f32 v[130:131], v[130:131], v[138:139]
    v_pk_mul_f32 v[132:133], v[132:133], v[140:141]
    v_pk_mul_f32 v[134:135], v[134:135], v[142:143]
    v_pk_add_f32 v[224:225], v[224:225], v[58:59]
    v_pk_add_f32 v[226:227], v[226:227], v[58:59]
    v_pk_add_f32 v[228:229], v[228:229], v[58:59]
    v_pk_add_f32 v[230:231], v[230:231], v[58:59]
    v_rcp_f32 v224, v224
    v_rcp_f32 v225, v225
    v_rcp_f32 v226, v226
    v_rcp_f32 v227, v227
    v_rcp_f32 v228, v228
    v_rcp_f32 v229, v229
    v_rcp_f32 v230, v230
    v_rcp_f32 v231, v231
    s_nop 0
    v_pk_mul_f32 v[128:129], v[128:129], v[224:225]
    v_pk_mul_f32 v[130:131], v[130:131], v[226:227]
    v_pk_mul_f32 v[132:133], v[132:133], v[228:229]
    v_pk_mul_f32 v[134:135], v[134:135], v[230:231]
    v_cvt_pk_bf16_f32 v44, v128, v129
    v_cvt_pk_bf16_f32 v45, v130, v131
    v_cvt_pk_bf16_f32 v46, v132, v133
    v_cvt_pk_bf16_f32 v47, v134, v135
    buffer_store_dwordx4 v[44:47], v56, s[76:79], 0 offen offset:2048 sc1
    v_pk_mul_f32 v[224:225], v[192:193], v[38:39]
    v_pk_mul_f32 v[226:227], v[194:195], v[38:39]
    v_pk_mul_f32 v[228:229], v[196:197], v[38:39]
    v_pk_mul_f32 v[230:231], v[198:199], v[38:39]
    v_pk_mul_f32 v[232:233], v[200:201], v[38:39]
    v_pk_mul_f32 v[234:235], v[202:203], v[38:39]
    v_pk_mul_f32 v[236:237], v[204:205], v[38:39]
    v_pk_mul_f32 v[238:239], v[206:207], v[38:39]
    v_pk_fma_f32 v[144:145], v[144:145], v[36:37], v[224:225]
    v_pk_fma_f32 v[146:147], v[146:147], v[36:37], v[226:227]
    v_pk_fma_f32 v[148:149], v[148:149], v[36:37], v[228:229]
    v_pk_fma_f32 v[150:151], v[150:151], v[36:37], v[230:231]
    v_pk_fma_f32 v[152:153], v[152:153], v[36:37], v[232:233]
    v_pk_fma_f32 v[154:155], v[154:155], v[36:37], v[234:235]
    v_pk_fma_f32 v[156:157], v[156:157], v[36:37], v[236:237]
    v_pk_fma_f32 v[158:159], v[158:159], v[36:37], v[238:239]
    v_pk_mul_f32 v[224:225], v[144:145], v[144:145]
    v_pk_mul_f32 v[226:227], v[146:147], v[146:147]
    v_pk_mul_f32 v[228:229], v[148:149], v[148:149]
    v_pk_mul_f32 v[230:231], v[150:151], v[150:151]
    v_pk_fma_f32 v[224:225], v[224:225], v[62:63], v[60:61]
    v_pk_fma_f32 v[226:227], v[226:227], v[62:63], v[60:61]
    v_pk_fma_f32 v[228:229], v[228:229], v[62:63], v[60:61]
    v_pk_fma_f32 v[230:231], v[230:231], v[62:63], v[60:61]
    v_pk_mul_f32 v[224:225], v[224:225], v[144:145]
    v_pk_mul_f32 v[226:227], v[226:227], v[146:147]
    v_pk_mul_f32 v[228:229], v[228:229], v[148:149]
    v_pk_mul_f32 v[230:231], v[230:231], v[150:151]
    v_exp_f32 v224, v224
    v_exp_f32 v225, v225
    v_exp_f32 v226, v226
    v_exp_f32 v227, v227
    v_exp_f32 v228, v228
    v_exp_f32 v229, v229
    v_exp_f32 v230, v230
    v_exp_f32 v231, v231
    v_pk_mul_f32 v[144:145], v[144:145], v[152:153]
    v_pk_mul_f32 v[146:147], v[146:147], v[154:155]
    v_pk_mul_f32 v[148:149], v[148:149], v[156:157]
    v_pk_mul_f32 v[150:151], v[150:151], v[158:159]
    v_pk_add_f32 v[224:225], v[224:225], v[58:59]
    v_pk_add_f32 v[226:227], v[226:227], v[58:59]
    v_pk_add_f32 v[228:229], v[228:229], v[58:59]
    v_pk_add_f32 v[230:231], v[230:231], v[58:59]
    v_rcp_f32 v224, v224
    v_rcp_f32 v225, v225
    v_rcp_f32 v226, v226
    v_rcp_f32 v227, v227
    v_rcp_f32 v228, v228
    v_rcp_f32 v229, v229
    v_rcp_f32 v230, v230
    v_rcp_f32 v231, v231
    s_nop 0
    v_pk_mul_f32 v[144:145], v[144:145], v[224:225]
    v_pk_mul_f32 v[146:147], v[146:147], v[226:227]
    v_pk_mul_f32 v[148:149], v[148:149], v[228:229]
    v_pk_mul_f32 v[150:151], v[150:151], v[230:231]
    v_cvt_pk_bf16_f32 v48, v144, v145
    v_cvt_pk_bf16_f32 v49, v146, v147
    v_cvt_pk_bf16_f32 v50, v148, v149
    v_cvt_pk_bf16_f32 v51, v150, v151
    buffer_store_dwordx4 v[48:51], v57, s[76:79], 0 offen offset:2048 sc1
    s_waitcnt lgkmcnt(0)
    v_pk_mul_f32 v[224:225], v[208:209], v[30:31]
    v_pk_mul_f32 v[226:227], v[210:211], v[30:31]
    v_pk_mul_f32 v[228:229], v[212:213], v[30:31]
    v_pk_mul_f32 v[230:231], v[214:215], v[30:31]
    v_pk_mul_f32 v[232:233], v[216:217], v[30:31]
    v_pk_mul_f32 v[234:235], v[218:219], v[30:31]
    v_pk_mul_f32 v[236:237], v[220:221], v[30:31]
    v_pk_mul_f32 v[238:239], v[222:223], v[30:31]
    v_pk_fma_f32 v[160:161], v[160:161], v[28:29], v[224:225]
    v_pk_fma_f32 v[162:163], v[162:163], v[28:29], v[226:227]
    v_pk_fma_f32 v[164:165], v[164:165], v[28:29], v[228:229]
    v_pk_fma_f32 v[166:167], v[166:167], v[28:29], v[230:231]
    v_pk_fma_f32 v[168:169], v[168:169], v[28:29], v[232:233]
    v_pk_fma_f32 v[170:171], v[170:171], v[28:29], v[234:235]
    v_pk_fma_f32 v[172:173], v[172:173], v[28:29], v[236:237]
    v_pk_fma_f32 v[174:175], v[174:175], v[28:29], v[238:239]
    v_pk_mul_f32 v[224:225], v[160:161], v[160:161]
    v_pk_mul_f32 v[226:227], v[162:163], v[162:163]
    v_pk_mul_f32 v[228:229], v[164:165], v[164:165]
    v_pk_mul_f32 v[230:231], v[166:167], v[166:167]
    v_pk_fma_f32 v[224:225], v[224:225], v[62:63], v[60:61]
    v_pk_fma_f32 v[226:227], v[226:227], v[62:63], v[60:61]
    v_pk_fma_f32 v[228:229], v[228:229], v[62:63], v[60:61]
    v_pk_fma_f32 v[230:231], v[230:231], v[62:63], v[60:61]
    v_pk_mul_f32 v[224:225], v[224:225], v[160:161]
    v_pk_mul_f32 v[226:227], v[226:227], v[162:163]
    v_pk_mul_f32 v[228:229], v[228:229], v[164:165]
    v_pk_mul_f32 v[230:231], v[230:231], v[166:167]
    v_exp_f32 v224, v224
    v_exp_f32 v225, v225
    v_exp_f32 v226, v226
    v_exp_f32 v227, v227
    v_exp_f32 v228, v228
    v_exp_f32 v229, v229
    v_exp_f32 v230, v230
    v_exp_f32 v231, v231
    v_pk_mul_f32 v[160:161], v[160:161], v[168:169]
    v_pk_mul_f32 v[162:163], v[162:163], v[170:171]
    v_pk_mul_f32 v[164:165], v[164:165], v[172:173]
    v_pk_mul_f32 v[166:167], v[166:167], v[174:175]
    v_pk_add_f32 v[224:225], v[224:225], v[58:59]
    v_pk_add_f32 v[226:227], v[226:227], v[58:59]
    v_pk_add_f32 v[228:229], v[228:229], v[58:59]
    v_pk_add_f32 v[230:231], v[230:231], v[58:59]
    v_rcp_f32 v224, v224
    v_rcp_f32 v225, v225
    v_rcp_f32 v226, v226
    v_rcp_f32 v227, v227
    v_rcp_f32 v228, v228
    v_rcp_f32 v229, v229
    v_rcp_f32 v230, v230
    v_rcp_f32 v231, v231
    s_nop 0
    v_pk_mul_f32 v[160:161], v[160:161], v[224:225]
    v_pk_mul_f32 v[162:163], v[162:163], v[226:227]
    v_pk_mul_f32 v[164:165], v[164:165], v[228:229]
    v_pk_mul_f32 v[166:167], v[166:167], v[230:231]
    v_cvt_pk_bf16_f32 v44, v160, v161
    v_cvt_pk_bf16_f32 v45, v162, v163
    v_cvt_pk_bf16_f32 v46, v164, v165
    v_cvt_pk_bf16_f32 v47, v166, v167
    buffer_store_dwordx4 v[44:47], v56, s[76:79], 0 offen offset:3072 sc1
    v_pk_mul_f32 v[224:225], v[208:209], v[38:39]
    v_pk_mul_f32 v[226:227], v[210:211], v[38:39]
    v_pk_mul_f32 v[228:229], v[212:213], v[38:39]
    v_pk_mul_f32 v[230:231], v[214:215], v[38:39]
    v_pk_mul_f32 v[232:233], v[216:217], v[38:39]
    v_pk_mul_f32 v[234:235], v[218:219], v[38:39]
    v_pk_mul_f32 v[236:237], v[220:221], v[38:39]
    v_pk_mul_f32 v[238:239], v[222:223], v[38:39]
    v_pk_fma_f32 v[176:177], v[176:177], v[36:37], v[224:225]
    v_pk_fma_f32 v[178:179], v[178:179], v[36:37], v[226:227]
    v_pk_fma_f32 v[180:181], v[180:181], v[36:37], v[228:229]
    v_pk_fma_f32 v[182:183], v[182:183], v[36:37], v[230:231]
    v_pk_fma_f32 v[184:185], v[184:185], v[36:37], v[232:233]
    v_pk_fma_f32 v[186:187], v[186:187], v[36:37], v[234:235]
    v_pk_fma_f32 v[188:189], v[188:189], v[36:37], v[236:237]
    v_pk_fma_f32 v[190:191], v[190:191], v[36:37], v[238:239]
    v_pk_mul_f32 v[224:225], v[176:177], v[176:177]
    v_pk_mul_f32 v[226:227], v[178:179], v[178:179]
    v_pk_mul_f32 v[228:229], v[180:181], v[180:181]
    v_pk_mul_f32 v[230:231], v[182:183], v[182:183]
    v_pk_fma_f32 v[224:225], v[224:225], v[62:63], v[60:61]
    v_pk_fma_f32 v[226:227], v[226:227], v[62:63], v[60:61]
    v_pk_fma_f32 v[228:229], v[228:229], v[62:63], v[60:61]
    v_pk_fma_f32 v[230:231], v[230:231], v[62:63], v[60:61]
    v_pk_mul_f32 v[224:225], v[224:225], v[176:177]
    v_pk_mul_f32 v[226:227], v[226:227], v[178:179]
    v_pk_mul_f32 v[228:229], v[228:229], v[180:181]
    v_pk_mul_f32 v[230:231], v[230:231], v[182:183]
    v_exp_f32 v224, v224
    v_exp_f32 v225, v225
    v_exp_f32 v226, v226
    v_exp_f32 v227, v227
    v_exp_f32 v228, v228
    v_exp_f32 v229, v229
    v_exp_f32 v230, v230
    v_exp_f32 v231, v231
    v_pk_mul_f32 v[176:177], v[176:177], v[184:185]
    v_pk_mul_f32 v[178:179], v[178:179], v[186:187]
    v_pk_mul_f32 v[180:181], v[180:181], v[188:189]
    v_pk_mul_f32 v[182:183], v[182:183], v[190:191]
    v_pk_add_f32 v[224:225], v[224:225], v[58:59]
    v_pk_add_f32 v[226:227], v[226:227], v[58:59]
    v_pk_add_f32 v[228:229], v[228:229], v[58:59]
    v_pk_add_f32 v[230:231], v[230:231], v[58:59]
    v_rcp_f32 v224, v224
    v_rcp_f32 v225, v225
    v_rcp_f32 v226, v226
    v_rcp_f32 v227, v227
    v_rcp_f32 v228, v228
    v_rcp_f32 v229, v229
    v_rcp_f32 v230, v230
    v_rcp_f32 v231, v231
    s_nop 0
    v_pk_mul_f32 v[176:177], v[176:177], v[224:225]
    v_pk_mul_f32 v[178:179], v[178:179], v[226:227]
    v_pk_mul_f32 v[180:181], v[180:181], v[228:229]
    v_pk_mul_f32 v[182:183], v[182:183], v[230:231]
    v_cvt_pk_bf16_f32 v48, v176, v177
    v_cvt_pk_bf16_f32 v49, v178, v179
    v_cvt_pk_bf16_f32 v50, v180, v181
    v_cvt_pk_bf16_f32 v51, v182, v183
    buffer_store_dwordx4 v[48:51], v57, s[76:79], 0 offen offset:3072 sc1
    s_branch L_k3_glu_kernel_fin_3
L_k3_glu_kernel_pathb_2:
    s_mov_b32 s97, -123904
    s_waitcnt vmcnt(12)
    s_barrier
    ds_read_b128 v[192:195], v14 offset:0
    ds_read_b64_tr_b16 v[200:201], v16 offset:0
    ds_read_b64_tr_b16 v[202:203], v16 offset:1792
    ds_read_b128 v[196:199], v14 offset:2048
    ds_read_b64_tr_b16 v[204:205], v16 offset:128
    ds_read_b64_tr_b16 v[206:207], v16 offset:1920
    ds_read_b64_tr_b16 v[208:209], v16 offset:256
    ds_read_b64_tr_b16 v[210:211], v16 offset:2048
    s_mov_b32 s54, 28
L_k3_glu_kernel_loop_5:
    s_waitcnt vmcnt(8)
    s_barrier
    s_waitcnt lgkmcnt(5)
    v_mfma_f32_32x32x16_bf16 v[64:79], v[200:203], v[192:195], v[64:79]
    ds_read_b128 v[216:219], v14 offset:1024
    ds_read_b64_tr_b16 v[224:225], v16 offset:3584
    s_add_u32 m0, s52, s40
    s_nop 0
    buffer_load_dwordx4 v10, s[8:11], s50 offen lds
    s_waitcnt lgkmcnt(6)
    v_mfma_f32_32x32x16_bf16 v[80:95], v[200:203], v[196:199], v[80:95]
    ds_read_b64_tr_b16 v[226:227], v16 offset:5376
    s_add_u32 m0, s52, s41
    s_nop 0
    buffer_load_dwordx4 v11, s[8:11], s50 offen lds
    s_waitcnt lgkmcnt(5)
    v_mfma_f32_32x32x16_bf16 v[96:111], v[204:207], v[192:195], v[96:111]
    ds_read_b128 v[220:223], v14 offset:3072
    s_and_b32 s95, s52, s57
    s_add_u32 m0, s95, s42
    s_nop 0
    buffer_load_dwordx4 v12, s[12:15], s51 offen lds
    v_mfma_f32_32x32x16_bf16 v[112:127], v[204:207], v[196:199], v[112:127]
    ds_read_b64_tr_b16 v[228:229], v16 offset:3712
    ds_read_b64_tr_b16 v[230:231], v16 offset:5504
    s_and_b32 s95, s52, s57
    s_add_u32 m0, s95, s43
    s_nop 0
    buffer_load_dwordx4 v12, s[16:19], s51 offen lds
    s_add_u32 s50, s50, 0x800
    s_add_u32 s51, s51, s56
    s_add_u32 s52, s52, 30976
    s_cmp_ge_u32 s52, 154880
    s_cselect_b32 s52, 0, s52
    s_waitcnt lgkmcnt(6)
    v_mfma_f32_32x32x16_bf16 v[128:143], v[208:211], v[192:195], v[128:143]
    ds_read_b64_tr_b16 v[232:233], v16 offset:3840
    v_mfma_f32_32x32x16_bf16 v[144:159], v[208:211], v[196:199], v[144:159]
    ds_read_b64_tr_b16 v[234:235], v16 offset:5632
    s_add_u32 s53, s53, 30976
    s_cmp_ge_u32 s53, 154880
    s_cselect_b32 s53, 0, s53
    s_cselect_b32 s96, s97, 30976
    v_add_u32 v14, s96, v14
    v_add_u32 v16, s96, v16
    s_waitcnt lgkmcnt(5)
    v_mfma_f32_32x32x16_bf16 v[64:79], v[224:227], v[216:219], v[64:79]
    ds_read_b128 v[192:195], v14 offset:0
    ds_read_b64_tr_b16 v[200:201], v16 offset:0
    s_waitcnt lgkmcnt(6)
    v_mfma_f32_32x32x16_bf16 v[80:95], v[224:227], v[220:223], v[80:95]
    ds_read_b64_tr_b16 v[202:203], v16 offset:1792
    s_waitcnt lgkmcnt(5)
    v_mfma_f32_32x32x16_bf16 v[96:111], v[228:231], v[216:219], v[96:111]
    ds_read_b128 v[196:199], v14 offset:2048
    v_mfma_f32_32x32x16_bf16 v[112:127], v[228:231], v[220:223], v[112:127]
    ds_read_b64_tr_b16 v[204:205], v16 offset:128
    ds_read_b64_tr_b16 v[206:207], v16 offset:1920
    s_waitcnt lgkmcnt(6)
    v_mfma_f32_32x32x16_bf16 v[128:143], v[232:235], v[216:219], v[128:143]
    ds_read_b64_tr_b16 v[208:209], v16 offset:256
    v_mfma_f32_32x32x16_bf16 v[144:159], v[232:235], v[220:223], v[144:159]
    ds_read_b64_tr_b16 v[210:211], v16 offset:2048
    s_sub_u32 s54, s54, 1
    s_cmp_lg_u32 s54, 0
    s_cbranch_scc1 L_k3_glu_kernel_loop_5
    s_waitcnt vmcnt(8)
    s_barrier
    s_waitcnt lgkmcnt(5)
    v_mfma_f32_32x32x16_bf16 v[64:79], v[200:203], v[192:195], v[64:79]
    ds_read_b128 v[216:219], v14 offset:1024
    ds_read_b64_tr_b16 v[224:225], v16 offset:3584
    s_waitcnt lgkmcnt(6)
    v_mfma_f32_32x32x16_bf16 v[80:95], v[200:203], v[196:199], v[80:95]
    ds_read_b64_tr_b16 v[226:227], v16 offset:5376
    s_waitcnt lgkmcnt(5)
    v_mfma_f32_32x32x16_bf16 v[96:111], v[204:207], v[192:195], v[96:111]
    ds_read_b128 v[220:223], v14 offset:3072
    v_mfma_f32_32x32x16_bf16 v[112:127], v[204:207], v[196:199], v[112:127]
    ds_read_b64_tr_b16 v[228:229], v16 offset:3712
    ds_read_b64_tr_b16 v[230:231], v16 offset:5504
    s_waitcnt lgkmcnt(6)
    v_mfma_f32_32x32x16_bf16 v[128:143], v[208:211], v[192:195], v[128:143]
    ds_read_b64_tr_b16 v[232:233], v16 offset:3840
    v_mfma_f32_32x32x16_bf16 v[144:159], v[208:211], v[196:199], v[144:159]
    ds_read_b64_tr_b16 v[234:235], v16 offset:5632
    s_add_u32 s53, s53, 30976
    s_cmp_ge_u32 s53, 154880
    s_cselect_b32 s53, 0, s53
    s_cselect_b32 s96, s97, 30976
    v_add_u32 v14, s96, v14
    v_add_u32 v16, s96, v16
    s_waitcnt lgkmcnt(5)
    v_mfma_f32_32x32x16_bf16 v[64:79], v[224:227], v[216:219], v[64:79]
    ds_read_b128 v[192:195], v14 offset:0
    ds_read_b64_tr_b16 v[200:201], v16 offset:0
    s_waitcnt lgkmcnt(6)
    v_mfma_f32_32x32x16_bf16 v[80:95], v[224:227], v[220:223], v[80:95]
    ds_read_b64_tr_b16 v[202:203], v16 offset:1792
    s_waitcnt lgkmcnt(5)
    v_mfma_f32_32x32x16_bf16 v[96:111], v[228:231], v[216:219], v[96:111]
    ds_read_b128 v[196:199], v14 offset:2048
    v_mfma_f32_32x32x16_bf16 v[112:127], v[228:231], v[220:223], v[112:127]
    ds_read_b64_tr_b16 v[204:205], v16 offset:128
    ds_read_b64_tr_b16 v[206:207], v16 offset:1920
    s_waitcnt lgkmcnt(6)
    v_mfma_f32_32x32x16_bf16 v[128:143], v[232:235], v[216:219], v[128:143]
    ds_read_b64_tr_b16 v[208:209], v16 offset:256
    v_mfma_f32_32x32x16_bf16 v[144:159], v[232:235], v[220:223], v[144:159]
    ds_read_b64_tr_b16 v[210:211], v16 offset:2048
    s_lshl_b32 s30, s26, 6
    s_add_u32 s30, s30, s24
    v_and_b32 v3, 31, v2
    v_add_u32 v3, s30, v3
    v_lshlrev_b32 v4, 3, v3
    v_lshrrev_b32 v5, 5, v2
    v_lshl_add_u32 v4, v5, 16, v4
    s_mov_b32 s31, 0
    buffer_load_dwordx2 v[24:25], v4, s[64:67], s31 offen
    buffer_load_dwordx2 v[32:33], v4, s[64:67], s31 offen offset:256
    s_add_u32 s31, s31, 16384
    buffer_load_dwordx2 v[26:27], v4, s[64:67], s31 offen
    buffer_load_dwordx2 v[34:35], v4, s[64:67], s31 offen offset:256
    s_add_u32 s31, s31, 16384
    buffer_load_dwordx2 v[28:29], v4, s[64:67], s31 offen
    buffer_load_dwordx2 v[36:37], v4, s[64:67], s31 offen offset:256
    s_add_u32 s31, s31, 16384
    buffer_load_dwordx2 v[30:31], v4, s[64:67], s31 offen
    buffer_load_dwordx2 v[38:39], v4, s[64:67], s31 offen offset:256
    s_add_u32 s31, s31, 16384
    v_cmp_gt_u32 vcc, 28, v2
    v_subrev_u32 v6, 28, v2
    s_nop 1
    v_cndmask_b32 v6, v6, v2, vcc
    v_lshlrev_b32 v6, 4, v6
    v_mov_b32 v7, 14336
    v_mov_b32 v8, 0
    v_cndmask_b32 v7, v7, v8, vcc
    v_add_u32 v6, v6, v7
    s_mul_i32 s31, s22, 448
    v_add_u32 v6, s31, v6
    s_mov_b32 s31, 0
    buffer_load_dwordx4 v[40:43], v6, s[68:71], s31 offen
    s_add_u32 s31, s31, 28672
    buffer_load_dwordx4 v[44:47], v6, s[68:71], s31 offen
    s_add_u32 s31, s31, 28672
    buffer_load_dwordx4 v[48:51], v6, s[68:71], s31 offen
    s_add_u32 s31, s31, 28672
    buffer_load_dwordx4 v[52:55], v6, s[68:71], s31 offen
    s_add_u32 s31, s31, 28672
    s_waitcnt vmcnt(16)
    s_barrier
    s_waitcnt lgkmcnt(5)
    v_mfma_f32_32x32x16_bf16 v[64:79], v[200:203], v[192:195], v[64:79]
    ds_read_b128 v[216:219], v14 offset:1024
    ds_read_b64_tr_b16 v[224:225], v16 offset:3584
    s_waitcnt lgkmcnt(6)
    v_mfma_f32_32x32x16_bf16 v[80:95], v[200:203], v[196:199], v[80:95]
    ds_read_b64_tr_b16 v[226:227], v16 offset:5376
    s_waitcnt lgkmcnt(5)
    v_mfma_f32_32x32x16_bf16 v[96:111], v[204:207], v[192:195], v[96:111]
    ds_read_b128 v[220:223], v14 offset:3072
    v_mfma_f32_32x32x16_bf16 v[112:127], v[204:207], v[196:199], v[112:127]
    ds_read_b64_tr_b16 v[228:229], v16 offset:3712
    ds_read_b64_tr_b16 v[230:231], v16 offset:5504
    s_waitcnt lgkmcnt(6)
    v_mfma_f32_32x32x16_bf16 v[128:143], v[208:211], v[192:195], v[128:143]
    ds_read_b64_tr_b16 v[232:233], v16 offset:3840
    v_mfma_f32_32x32x16_bf16 v[144:159], v[208:211], v[196:199], v[144:159]
    ds_read_b64_tr_b16 v[234:235], v16 offset:5632
    s_add_u32 s53, s53, 30976
    s_cmp_ge_u32 s53, 154880
    s_cselect_b32 s53, 0, s53
    s_cselect_b32 s96, s97, 30976
    v_add_u32 v14, s96, v14
    v_add_u32 v16, s96, v16
    s_waitcnt lgkmcnt(5)
    v_mfma_f32_32x32x16_bf16 v[64:79], v[224:227], v[216:219], v[64:79]
    ds_read_b128 v[192:195], v14 offset:0
    ds_read_b64_tr_b16 v[200:201], v16 offset:0
    s_waitcnt lgkmcnt(6)
    v_mfma_f32_32x32x16_bf16 v[80:95], v[224:227], v[220:223], v[80:95]
    ds_read_b64_tr_b16 v[202:203], v16 offset:1792
    s_waitcnt lgkmcnt(5)
    v_mfma_f32_32x32x16_bf16 v[96:111], v[228:231], v[216:219], v[96:111]
    ds_read_b128 v[196:199], v14 offset:2048
    v_mfma_f32_32x32x16_bf16 v[112:127], v[228:231], v[220:223], v[112:127]
    ds_read_b64_tr_b16 v[204:205], v16 offset:128
    ds_read_b64_tr_b16 v[206:207], v16 offset:1920
    s_waitcnt lgkmcnt(6)
    v_mfma_f32_32x32x16_bf16 v[128:143], v[232:235], v[216:219], v[128:143]
    ds_read_b64_tr_b16 v[208:209], v16 offset:256
    v_mfma_f32_32x32x16_bf16 v[144:159], v[232:235], v[220:223], v[144:159]
    ds_read_b64_tr_b16 v[210:211], v16 offset:2048
    s_waitcnt vmcnt(12)
    s_barrier
    s_waitcnt lgkmcnt(5)
    v_mfma_f32_32x32x16_bf16 v[64:79], v[200:203], v[192:195], v[64:79]
    ds_read_b128 v[216:219], v14 offset:1024
    ds_read_b64_tr_b16 v[224:225], v16 offset:3584
    s_waitcnt lgkmcnt(6)
    v_mfma_f32_32x32x16_bf16 v[80:95], v[200:203], v[196:199], v[80:95]
    ds_read_b64_tr_b16 v[226:227], v16 offset:5376
    s_waitcnt lgkmcnt(5)
    v_mfma_f32_32x32x16_bf16 v[96:111], v[204:207], v[192:195], v[96:111]
    ds_read_b128 v[220:223], v14 offset:3072
    v_mfma_f32_32x32x16_bf16 v[112:127], v[204:207], v[196:199], v[112:127]
    ds_read_b64_tr_b16 v[228:229], v16 offset:3712
    ds_read_b64_tr_b16 v[230:231], v16 offset:5504
    s_waitcnt lgkmcnt(6)
    v_mfma_f32_32x32x16_bf16 v[128:143], v[208:211], v[192:195], v[128:143]
    ds_read_b64_tr_b16 v[232:233], v16 offset:3840
    v_mfma_f32_32x32x16_bf16 v[144:159], v[208:211], v[196:199], v[144:159]
    ds_read_b64_tr_b16 v[234:235], v16 offset:5632
    s_add_u32 s53, s53, 30976
    s_cmp_ge_u32 s53, 154880
    s_cselect_b32 s53, 0, s53
    s_cselect_b32 s96, s97, 30976
    v_add_u32 v14, s96, v14
    v_add_u32 v16, s96, v16
    s_waitcnt lgkmcnt(5)
    v_mfma_f32_32x32x16_bf16 v[64:79], v[224:227], v[216:219], v[64:79]
    ds_read_b128 v[192:195], v14 offset:0
    ds_read_b64_tr_b16 v[200:201], v16 offset:0
    s_waitcnt lgkmcnt(6)
    v_mfma_f32_32x32x16_bf16 v[80:95], v[224:227], v[220:223], v[80:95]
    ds_read_b64_tr_b16 v[202:203], v16 offset:1792
    s_waitcnt lgkmcnt(5)
    v_mfma_f32_32x32x16_bf16 v[96:111], v[228:231], v[216:219], v[96:111]
    ds_read_b128 v[196:199], v14 offset:2048
    v_mfma_f32_32x32x16_bf16 v[112:127], v[228:231], v[220:223], v[112:127]
    ds_read_b64_tr_b16 v[204:205], v16 offset:128
    ds_read_b64_tr_b16 v[206:207], v16 offset:1920
    s_waitcnt lgkmcnt(6)
    v_mfma_f32_32x32x16_bf16 v[128:143], v[232:235], v[216:219], v[128:143]
    ds_read_b64_tr_b16 v[208:209], v16 offset:256
    v_mfma_f32_32x32x16_bf16 v[144:159], v[232:235], v[220:223], v[144:159]
    ds_read_b64_tr_b16 v[210:211], v16 offset:2048
    s_waitcnt vmcnt(12)
    s_barrier
    s_waitcnt lgkmcnt(5)
    v_mfma_f32_32x32x16_bf16 v[64:79], v[200:203], v[192:195], v[64:79]
    ds_read_b128 v[216:219], v14 offset:1024
    ds_read_b64_tr_b16 v[224:225], v16 offset:3584
    s_waitcnt lgkmcnt(6)
    v_mfma_f32_32x32x16_bf16 v[80:95], v[200:203], v[196:199], v[80:95]
    ds_read_b64_tr_b16 v[226:227], v16 offset:5376
    s_waitcnt lgkmcnt(5)
    v_mfma_f32_32x32x16_bf16 v[96:111], v[204:207], v[192:195], v[96:111]
    ds_read_b128 v[220:223], v14 offset:3072
    v_mfma_f32_32x32x16_bf16 v[112:127], v[204:207], v[196:199], v[112:127]
    ds_read_b64_tr_b16 v[228:229], v16 offset:3712
    ds_read_b64_tr_b16 v[230:231], v16 offset:5504
    s_waitcnt lgkmcnt(6)
    v_mfma_f32_32x32x16_bf16 v[128:143], v[208:211], v[192:195], v[128:143]
    ds_read_b64_tr_b16 v[232:233], v16 offset:3840
    v_mfma_f32_32x32x16_bf16 v[144:159], v[208:211], v[196:199], v[144:159]
    ds_read_b64_tr_b16 v[234:235], v16 offset:5632
    s_waitcnt lgkmcnt(5)
    v_mfma_f32_32x32x16_bf16 v[64:79], v[224:227], v[216:219], v[64:79]
    s_waitcnt lgkmcnt(4)
    v_mfma_f32_32x32x16_bf16 v[80:95], v[224:227], v[220:223], v[80:95]
    s_waitcnt lgkmcnt(2)
    v_mfma_f32_32x32x16_bf16 v[96:111], v[228:231], v[216:219], v[96:111]
    v_mfma_f32_32x32x16_bf16 v[112:127], v[228:231], v[220:223], v[112:127]
    s_waitcnt lgkmcnt(0)
    v_mfma_f32_32x32x16_bf16 v[128:143], v[232:235], v[216:219], v[128:143]
    v_mfma_f32_32x32x16_bf16 v[144:159], v[232:235], v[220:223], v[144:159]
    s_waitcnt vmcnt(0)
    v_pk_add_f32 v[40:41], v[40:41], v[44:45]
    v_pk_add_f32 v[48:49], v[48:49], v[52:53]
    v_pk_add_f32 v[40:41], v[40:41], v[48:49]
    v_pk_add_f32 v[42:43], v[42:43], v[46:47]
    v_pk_add_f32 v[50:51], v[50:51], v[54:55]
    v_pk_add_f32 v[42:43], v[42:43], v[50:51]
    v_add_u32 v6, 154880, v9
    v_cmp_gt_u32 vcc, 56, v2
    s_and_saveexec_b64 s[36:37], vcc
    ds_write_b128 v6, v[40:43]
    s_mov_b64 exec, s[36:37]
    v_pk_add_f32 v[24:25], v[24:25], v[26:27]
    v_pk_add_f32 v[28:29], v[28:29], v[30:31]
    v_pk_add_f32 v[24:25], v[24:25], v[28:29]
    v_mov_b32 v26, v24
    v_mov_b32 v27, v25
    v_pk_add_f32 v[32:33], v[32:33], v[34:35]
    v_pk_add_f32 v[36:37], v[36:37], v[38:39]
    v_pk_add_f32 v[32:33], v[32:33], v[36:37]
    v_mov_b32 v34, v32
    v_mov_b32 v35, v33
    s_nop 1
    v_permlane32_swap_b32 v24, v26
    v_permlane32_swap_b32 v25, v27
    v_permlane32_swap_b32 v32, v34
    v_permlane32_swap_b32 v33, v35
    s_nop 1
    v_pk_add_f32 v[24:25], v[24:25], v[26:27]
    v_pk_add_f32 v[32:33], v[32:33], v[34:35]
    s_waitcnt lgkmcnt(0)
    s_barrier
    v_lshrrev_b32 v6, 5, v2
    v_lshlrev_b32 v5, 4, v6
    v_add_u32 v5, 155136, v5
    ds_read_b128 v[192:195], v5 offset:0
    ds_read_b128 v[200:203], v5 offset:448
    ds_read_b128 v[196:199], v5 offset:32
    ds_read_b128 v[204:207], v5 offset:480
    ds_read_b128 v[208:211], v5 offset:64
    ds_read_b128 v[216:219], v5 offset:512
    ds_read_b128 v[212:215], v5 offset:96
    ds_read_b128 v[220:223], v5 offset:544
    v_mul_f32 v24, 0x3a800000, v24
    v_mul_f32 v25, 0x3a800000, v25
    v_fma_f32 v25, -v24, v24, v25
    v_max_f32 v25, 0, v25
    v_cvt_pk_bf16_f32 v24, v24, v24
    v_lshlrev_b32 v24, 16, v24
    v_cvt_pk_bf16_f32 v25, v25, v25
    v_lshlrev_b32 v25, 16, v25
    v_add_f32 v25, 0x3727c5ac, v25
    v_cvt_pk_bf16_f32 v25, v25, v25
    v_lshlrev_b32 v25, 16, v25
    v_sqrt_f32 v25, v25
    s_nop 0
    v_cvt_pk_bf16_f32 v25, v25, v25
    v_lshlrev_b32 v25, 16, v25
    v_rcp_f32 v28, v25
    s_nop 0
    v_mov_b32 v29, v28
    v_mul_f32 v24, v24, v28
    v_sub_f32 v30, 0, v24
    v_mov_b32 v31, v30
    v_mul_f32 v32, 0x3a800000, v32
    v_mul_f32 v33, 0x3a800000, v33
    v_fma_f32 v33, -v32, v32, v33
    v_max_f32 v33, 0, v33
    v_cvt_pk_bf16_f32 v32, v32, v32
    v_lshlrev_b32 v32, 16, v32
    v_cvt_pk_bf16_f32 v33, v33, v33
    v_lshlrev_b32 v33, 16, v33
    v_add_f32 v33, 0x3727c5ac, v33
    v_cvt_pk_bf16_f32 v33, v33, v33
    v_lshlrev_b32 v33, 16, v33
    v_sqrt_f32 v33, v33
    s_nop 0
    v_cvt_pk_bf16_f32 v33, v33, v33
    v_lshlrev_b32 v33, 16, v33
    v_rcp_f32 v36, v33
    s_nop 0
    v_mov_b32 v37, v36
    v_mul_f32 v32, v32, v36
    v_sub_f32 v38, 0, v32
    v_mov_b32 v39, v38
    s_lshl_b32 s31, s23, 3
    s_lshl_b32 s30, s26, 1
    s_add_u32 s31, s31, s30
    s_mul_i32 s31, s31, 224
    s_mul_i32 s30, s22, 7
    s_add_u32 s31, s31, s30
    s_add_u32 s31, s31, 4
    s_lshl_b32 s31, s31, 10
    v_add_u32 v56, s31, v9
    v_add_u32 v57, 229376, v56
    v_mov_b32 v60, 0xc0135761
    v_mov_b32 v61, 0xc0135761
    v_mov_b32 v62, 0xbdd2d3e8
    v_mov_b32 v63, 0xbdd2d3e8
    v_mov_b32 v58, 1.0
    v_mov_b32 v59, 1.0
    s_waitcnt lgkmcnt(4)
    v_pk_mul_f32 v[224:225], v[192:193], v[30:31]
    v_pk_mul_f32 v[226:227], v[194:195], v[30:31]
    v_pk_mul_f32 v[228:229], v[196:197], v[30:31]
    v_pk_mul_f32 v[230:231], v[198:199], v[30:31]
    v_pk_mul_f32 v[232:233], v[200:201], v[30:31]
    v_pk_mul_f32 v[234:235], v[202:203], v[30:31]
    v_pk_mul_f32 v[236:237], v[204:205], v[30:31]
    v_pk_mul_f32 v[238:239], v[206:207], v[30:31]
    v_pk_fma_f32 v[64:65], v[64:65], v[28:29], v[224:225]
    v_pk_fma_f32 v[66:67], v[66:67], v[28:29], v[226:227]
    v_pk_fma_f32 v[68:69], v[68:69], v[28:29], v[228:229]
    v_pk_fma_f32 v[70:71], v[70:71], v[28:29], v[230:231]
    v_pk_fma_f32 v[72:73], v[72:73], v[28:29], v[232:233]
    v_pk_fma_f32 v[74:75], v[74:75], v[28:29], v[234:235]
    v_pk_fma_f32 v[76:77], v[76:77], v[28:29], v[236:237]
    v_pk_fma_f32 v[78:79], v[78:79], v[28:29], v[238:239]
    v_pk_mul_f32 v[224:225], v[64:65], v[64:65]
    v_pk_mul_f32 v[226:227], v[66:67], v[66:67]
    v_pk_mul_f32 v[228:229], v[68:69], v[68:69]
    v_pk_mul_f32 v[230:231], v[70:71], v[70:71]
    v_pk_fma_f32 v[224:225], v[224:225], v[62:63], v[60:61]
    v_pk_fma_f32 v[226:227], v[226:227], v[62:63], v[60:61]
    v_pk_fma_f32 v[228:229], v[228:229], v[62:63], v[60:61]
    v_pk_fma_f32 v[230:231], v[230:231], v[62:63], v[60:61]
    v_pk_mul_f32 v[224:225], v[224:225], v[64:65]
    v_pk_mul_f32 v[226:227], v[226:227], v[66:67]
    v_pk_mul_f32 v[228:229], v[228:229], v[68:69]
    v_pk_mul_f32 v[230:231], v[230:231], v[70:71]
    v_exp_f32 v224, v224
    v_exp_f32 v225, v225
    v_exp_f32 v226, v226
    v_exp_f32 v227, v227
    v_exp_f32 v228, v228
    v_exp_f32 v229, v229
    v_exp_f32 v230, v230
    v_exp_f32 v231, v231
    v_pk_mul_f32 v[64:65], v[64:65], v[72:73]
    v_pk_mul_f32 v[66:67], v[66:67], v[74:75]
    v_pk_mul_f32 v[68:69], v[68:69], v[76:77]
    v_pk_mul_f32 v[70:71], v[70:71], v[78:79]
    v_pk_add_f32 v[224:225], v[224:225], v[58:59]
    v_pk_add_f32 v[226:227], v[226:227], v[58:59]
    v_pk_add_f32 v[228:229], v[228:229], v[58:59]
    v_pk_add_f32 v[230:231], v[230:231], v[58:59]
    v_rcp_f32 v224, v224
    v_rcp_f32 v225, v225
    v_rcp_f32 v226, v226
    v_rcp_f32 v227, v227
    v_rcp_f32 v228, v228
    v_rcp_f32 v229, v229
    v_rcp_f32 v230, v230
    v_rcp_f32 v231, v231
    s_nop 0
    v_pk_mul_f32 v[64:65], v[64:65], v[224:225]
    v_pk_mul_f32 v[66:67], v[66:67], v[226:227]
    v_pk_mul_f32 v[68:69], v[68:69], v[228:229]
    v_pk_mul_f32 v[70:71], v[70:71], v[230:231]
    v_cvt_pk_bf16_f32 v44, v64, v65
    v_cvt_pk_bf16_f32 v45, v66, v67
    v_cvt_pk_bf16_f32 v46, v68, v69
    v_cvt_pk_bf16_f32 v47, v70, v71
    buffer_store_dwordx4 v[44:47], v56, s[76:79], 0 offen offset:0 sc1
    v_pk_mul_f32 v[224:225], v[192:193], v[38:39]
    v_pk_mul_f32 v[226:227], v[194:195], v[38:39]
    v_pk_mul_f32 v[228:229], v[196:197], v[38:39]
    v_pk_mul_f32 v[230:231], v[198:199], v[38:39]
    v_pk_mul_f32 v[232:233], v[200:201], v[38:39]
    v_pk_mul_f32 v[234:235], v[202:203], v[38:39]
    v_pk_mul_f32 v[236:237], v[204:205], v[38:39]
    v_pk_mul_f32 v[238:239], v[206:207], v[38:39]
    v_pk_fma_f32 v[80:81], v[80:81], v[36:37], v[224:225]
    v_pk_fma_f32 v[82:83], v[82:83], v[36:37], v[226:227]
    v_pk_fma_f32 v[84:85], v[84:85], v[36:37], v[228:229]
    v_pk_fma_f32 v[86:87], v[86:87], v[36:37], v[230:231]
    v_pk_fma_f32 v[88:89], v[88:89], v[36:37], v[232:233]
    v_pk_fma_f32 v[90:91], v[90:91], v[36:37], v[234:235]
    v_pk_fma_f32 v[92:93], v[92:93], v[36:37], v[236:237]
    v_pk_fma_f32 v[94:95], v[94:95], v[36:37], v[238:239]
    ds_read_b128 v[192:195], v5 offset:128
    ds_read_b128 v[200:203], v5 offset:576
    ds_read_b128 v[196:199], v5 offset:160
    ds_read_b128 v[204:207], v5 offset:608
    v_pk_mul_f32 v[224:225], v[80:81], v[80:81]
    v_pk_mul_f32 v[226:227], v[82:83], v[82:83]
    v_pk_mul_f32 v[228:229], v[84:85], v[84:85]
    v_pk_mul_f32 v[230:231], v[86:87], v[86:87]
    v_pk_fma_f32 v[224:225], v[224:225], v[62:63], v[60:61]
    v_pk_fma_f32 v[226:227], v[226:227], v[62:63], v[60:61]
    v_pk_fma_f32 v[228:229], v[228:229], v[62:63], v[60:61]
    v_pk_fma_f32 v[230:231], v[230:231], v[62:63], v[60:61]
    v_pk_mul_f32 v[224:225], v[224:225], v[80:81]
    v_pk_mul_f32 v[226:227], v[226:227], v[82:83]
    v_pk_mul_f32 v[228:229], v[228:229], v[84:85]
    v_pk_mul_f32 v[230:231], v[230:231], v[86:87]
    v_exp_f32 v224, v224
    v_exp_f32 v225, v225
    v_exp_f32 v226, v226
    v_exp_f32 v227, v227
    v_exp_f32 v228, v228
    v_exp_f32 v229, v229
    v_exp_f32 v230, v230
    v_exp_f32 v231, v231
    v_pk_mul_f32 v[80:81], v[80:81], v[88:89]
    v_pk_mul_f32 v[82:83], v[82:83], v[90:91]
    v_pk_mul_f32 v[84:85], v[84:85], v[92:93]
    v_pk_mul_f32 v[86:87], v[86:87], v[94:95]
    v_pk_add_f32 v[224:225], v[224:225], v[58:59]
    v_pk_add_f32 v[226:227], v[226:227], v[58:59]
    v_pk_add_f32 v[228:229], v[228:229], v[58:59]
    v_pk_add_f32 v[230:231], v[230:231], v[58:59]
    v_rcp_f32 v224, v224
    v_rcp_f32 v225, v225
    v_rcp_f32 v226, v226
    v_rcp_f32 v227, v227
    v_rcp_f32 v228, v228
    v_rcp_f32 v229, v229
    v_rcp_f32 v230, v230
    v_rcp_f32 v231, v231
    s_nop 0
    v_pk_mul_f32 v[80:81], v[80:81], v[224:225]
    v_pk_mul_f32 v[82:83], v[82:83], v[226:227]
    v_pk_mul_f32 v[84:85], v[84:85], v[228:229]
    v_pk_mul_f32 v[86:87], v[86:87], v[230:231]
    v_cvt_pk_bf16_f32 v48, v80, v81
    v_cvt_pk_bf16_f32 v49, v82, v83
    v_cvt_pk_bf16_f32 v50, v84, v85
    v_cvt_pk_bf16_f32 v51, v86, v87
    buffer_store_dwordx4 v[48:51], v57, s[76:79], 0 offen offset:0 sc1
    s_waitcnt lgkmcnt(4)
    v_pk_mul_f32 v[224:225], v[208:209], v[30:31]
    v_pk_mul_f32 v[226:227], v[210:211], v[30:31]
    v_pk_mul_f32 v[228:229], v[212:213], v[30:31]
    v_pk_mul_f32 v[230:231], v[214:215], v[30:31]
    v_pk_mul_f32 v[232:233], v[216:217], v[30:31]
    v_pk_mul_f32 v[234:235], v[218:219], v[30:31]
    v_pk_mul_f32 v[236:237], v[220:221], v[30:31]
    v_pk_mul_f32 v[238:239], v[222:223], v[30:31]
    v_pk_fma_f32 v[96:97], v[96:97], v[28:29], v[224:225]
    v_pk_fma_f32 v[98:99], v[98:99], v[28:29], v[226:227]
    v_pk_fma_f32 v[100:101], v[100:101], v[28:29], v[228:229]
    v_pk_fma_f32 v[102:103], v[102:103], v[28:29], v[230:231]
    v_pk_fma_f32 v[104:105], v[104:105], v[28:29], v[232:233]
    v_pk_fma_f32 v[106:107], v[106:107], v[28:29], v[234:235]
    v_pk_fma_f32 v[108:109], v[108:109], v[28:29], v[236:237]
    v_pk_fma_f32 v[110:111], v[110:111], v[28:29], v[238:239]
    v_pk_mul_f32 v[224:225], v[96:97], v[96:97]
    v_pk_mul_f32 v[226:227], v[98:99], v[98:99]
    v_pk_mul_f32 v[228:229], v[100:101], v[100:101]
    v_pk_mul_f32 v[230:231], v[102:103], v[102:103]
    v_pk_fma_f32 v[224:225], v[224:225], v[62:63], v[60:61]
    v_pk_fma_f32 v[226:227], v[226:227], v[62:63], v[60:61]
    v_pk_fma_f32 v[228:229], v[228:229], v[62:63], v[60:61]
    v_pk_fma_f32 v[230:231], v[230:231], v[62:63], v[60:61]
    v_pk_mul_f32 v[224:225], v[224:225], v[96:97]
    v_pk_mul_f32 v[226:227], v[226:227], v[98:99]
    v_pk_mul_f32 v[228:229], v[228:229], v[100:101]
    v_pk_mul_f32 v[230:231], v[230:231], v[102:103]
    v_exp_f32 v224, v224
    v_exp_f32 v225, v225
    v_exp_f32 v226, v226
    v_exp_f32 v227, v227
    v_exp_f32 v228, v228
    v_exp_f32 v229, v229
    v_exp_f32 v230, v230
    v_exp_f32 v231, v231
    v_pk_mul_f32 v[96:97], v[96:97], v[104:105]
    v_pk_mul_f32 v[98:99], v[98:99], v[106:107]
    v_pk_mul_f32 v[100:101], v[100:101], v[108:109]
    v_pk_mul_f32 v[102:103], v[102:103], v[110:111]
    v_pk_add_f32 v[224:225], v[224:225], v[58:59]
    v_pk_add_f32 v[226:227], v[226:227], v[58:59]
    v_pk_add_f32 v[228:229], v[228:229], v[58:59]
    v_pk_add_f32 v[230:231], v[230:231], v[58:59]
    v_rcp_f32 v224, v224
    v_rcp_f32 v225, v225
    v_rcp_f32 v226, v226
    v_rcp_f32 v227, v227
    v_rcp_f32 v228, v228
    v_rcp_f32 v229, v229
    v_rcp_f32 v230, v230
    v_rcp_f32 v231, v231
    s_nop 0
    v_pk_mul_f32 v[96:97], v[96:97], v[224:225]
    v_pk_mul_f32 v[98:99], v[98:99], v[226:227]
    v_pk_mul_f32 v[100:101], v[100:101], v[228:229]
    v_pk_mul_f32 v[102:103], v[102:103], v[230:231]
    v_cvt_pk_bf16_f32 v44, v96, v97
    v_cvt_pk_bf16_f32 v45, v98, v99
    v_cvt_pk_bf16_f32 v46, v100, v101
    v_cvt_pk_bf16_f32 v47, v102, v103
    buffer_store_dwordx4 v[44:47], v56, s[76:79], 0 offen offset:1024 sc1
    v_pk_mul_f32 v[224:225], v[208:209], v[38:39]
    v_pk_mul_f32 v[226:227], v[210:211], v[38:39]
    v_pk_mul_f32 v[228:229], v[212:213], v[38:39]
    v_pk_mul_f32 v[230:231], v[214:215], v[38:39]
    v_pk_mul_f32 v[232:233], v[216:217], v[38:39]
    v_pk_mul_f32 v[234:235], v[218:219], v[38:39]
    v_pk_mul_f32 v[236:237], v[220:221], v[38:39]
    v_pk_mul_f32 v[238:239], v[222:223], v[38:39]
    v_pk_fma_f32 v[112:113], v[112:113], v[36:37], v[224:225]
    v_pk_fma_f32 v[114:115], v[114:115], v[36:37], v[226:227]
    v_pk_fma_f32 v[116:117], v[116:117], v[36:37], v[228:229]
    v_pk_fma_f32 v[118:119], v[118:119], v[36:37], v[230:231]
    v_pk_fma_f32 v[120:121], v[120:121], v[36:37], v[232:233]
    v_pk_fma_f32 v[122:123], v[122:123], v[36:37], v[234:235]
    v_pk_fma_f32 v[124:125], v[124:125], v[36:37], v[236:237]
    v_pk_fma_f32 v[126:127], v[126:127], v[36:37], v[238:239]
    v_pk_mul_f32 v[224:225], v[112:113], v[112:113]
    v_pk_mul_f32 v[226:227], v[114:115], v[114:115]
    v_pk_mul_f32 v[228:229], v[116:117], v[116:117]
    v_pk_mul_f32 v[230:231], v[118:119], v[118:119]
    v_pk_fma_f32 v[224:225], v[224:225], v[62:63], v[60:61]
    v_pk_fma_f32 v[226:227], v[226:227], v[62:63], v[60:61]
    v_pk_fma_f32 v[228:229], v[228:229], v[62:63], v[60:61]
    v_pk_fma_f32 v[230:231], v[230:231], v[62:63], v[60:61]
    v_pk_mul_f32 v[224:225], v[224:225], v[112:113]
    v_pk_mul_f32 v[226:227], v[226:227], v[114:115]
    v_pk_mul_f32 v[228:229], v[228:229], v[116:117]
    v_pk_mul_f32 v[230:231], v[230:231], v[118:119]
    v_exp_f32 v224, v224
    v_exp_f32 v225, v225
    v_exp_f32 v226, v226
    v_exp_f32 v227, v227
    v_exp_f32 v228, v228
    v_exp_f32 v229, v229
    v_exp_f32 v230, v230
    v_exp_f32 v231, v231
    v_pk_mul_f32 v[112:113], v[112:113], v[120:121]
    v_pk_mul_f32 v[114:115], v[114:115], v[122:123]
    v_pk_mul_f32 v[116:117], v[116:117], v[124:125]
    v_pk_mul_f32 v[118:119], v[118:119], v[126:127]
    v_pk_add_f32 v[224:225], v[224:225], v[58:59]
    v_pk_add_f32 v[226:227], v[226:227], v[58:59]
    v_pk_add_f32 v[228:229], v[228:229], v[58:59]
    v_pk_add_f32 v[230:231], v[230:231], v[58:59]
    v_rcp_f32 v224, v224
    v_rcp_f32 v225, v225
    v_rcp_f32 v226, v226
    v_rcp_f32 v227, v227
    v_rcp_f32 v228, v228
    v_rcp_f32 v229, v229
    v_rcp_f32 v230, v230
    v_rcp_f32 v231, v231
    s_nop 0
    v_pk_mul_f32 v[112:113], v[112:113], v[224:225]
    v_pk_mul_f32 v[114:115], v[114:115], v[226:227]
    v_pk_mul_f32 v[116:117], v[116:117], v[228:229]
    v_pk_mul_f32 v[118:119], v[118:119], v[230:231]
    v_cvt_pk_bf16_f32 v48, v112, v113
    v_cvt_pk_bf16_f32 v49, v114, v115
    v_cvt_pk_bf16_f32 v50, v116, v117
    v_cvt_pk_bf16_f32 v51, v118, v119
    buffer_store_dwordx4 v[48:51], v57, s[76:79], 0 offen offset:1024 sc1
    s_waitcnt lgkmcnt(0)
    v_pk_mul_f32 v[224:225], v[192:193], v[30:31]
    v_pk_mul_f32 v[226:227], v[194:195], v[30:31]
    v_pk_mul_f32 v[228:229], v[196:197], v[30:31]
    v_pk_mul_f32 v[230:231], v[198:199], v[30:31]
    v_pk_mul_f32 v[232:233], v[200:201], v[30:31]
    v_pk_mul_f32 v[234:235], v[202:203], v[30:31]
    v_pk_mul_f32 v[236:237], v[204:205], v[30:31]
    v_pk_mul_f32 v[238:239], v[206:207], v[30:31]
    v_pk_fma_f32 v[128:129], v[128:129], v[28:29], v[224:225]
    v_pk_fma_f32 v[130:131], v[130:131], v[28:29], v[226:227]
    v_pk_fma_f32 v[132:133], v[132:133], v[28:29], v[228:229]
    v_pk_fma_f32 v[134:135], v[134:135], v[28:29], v[230:231]
    v_pk_fma_f32 v[136:137], v[136:137], v[28:29], v[232:233]
    v_pk_fma_f32 v[138:139], v[138:139], v[28:29], v[234:235]
    v_pk_fma_f32 v[140:141], v[140:141], v[28:29], v[236:237]
    v_pk_fma_f32 v[142:143], v[142:143], v[28:29], v[238:239]
    v_pk_mul_f32 v[224:225], v[128:129], v[128:129]
    v_pk_mul_f32 v[226:227], v[130:131], v[130:131]
    v_pk_mul_f32 v[228:229], v[132:133], v[132:133]
    v_pk_mul_f32 v[230:231], v[134:135], v[134:135]
    v_pk_fma_f32 v[224:225], v[224:225], v[62:63], v[60:61]
    v_pk_fma_f32 v[226:227], v[226:227], v[62:63], v[60:61]
    v_pk_fma_f32 v[228:229], v[228:229], v[62:63], v[60:61]
    v_pk_fma_f32 v[230:231], v[230:231], v[62:63], v[60:61]
    v_pk_mul_f32 v[224:225], v[224:225], v[128:129]
    v_pk_mul_f32 v[226:227], v[226:227], v[130:131]
    v_pk_mul_f32 v[228:229], v[228:229], v[132:133]
    v_pk_mul_f32 v[230:231], v[230:231], v[134:135]
    v_exp_f32 v224, v224
    v_exp_f32 v225, v225
    v_exp_f32 v226, v226
    v_exp_f32 v227, v227
    v_exp_f32 v228, v228
    v_exp_f32 v229, v229
    v_exp_f32 v230, v230
    v_exp_f32 v231, v231
    v_pk_mul_f32 v[128:129], v[128:129], v[136:137]
    v_pk_mul_f32 v[130:131], v[130:131], v[138:139]
    v_pk_mul_f32 v[132:133], v[132:133], v[140:141]
    v_pk_mul_f32 v[134:135], v[134:135], v[142:143]
    v_pk_add_f32 v[224:225], v[224:225], v[58:59]
    v_pk_add_f32 v[226:227], v[226:227], v[58:59]
    v_pk_add_f32 v[228:229], v[228:229], v[58:59]
    v_pk_add_f32 v[230:231], v[230:231], v[58:59]
    v_rcp_f32 v224, v224
    v_rcp_f32 v225, v225
    v_rcp_f32 v226, v226
    v_rcp_f32 v227, v227
    v_rcp_f32 v228, v228
    v_rcp_f32 v229, v229
    v_rcp_f32 v230, v230
    v_rcp_f32 v231, v231
    s_nop 0
    v_pk_mul_f32 v[128:129], v[128:129], v[224:225]
    v_pk_mul_f32 v[130:131], v[130:131], v[226:227]
    v_pk_mul_f32 v[132:133], v[132:133], v[228:229]
    v_pk_mul_f32 v[134:135], v[134:135], v[230:231]
    v_cvt_pk_bf16_f32 v44, v128, v129
    v_cvt_pk_bf16_f32 v45, v130, v131
    v_cvt_pk_bf16_f32 v46, v132, v133
    v_cvt_pk_bf16_f32 v47, v134, v135
    buffer_store_dwordx4 v[44:47], v56, s[76:79], 0 offen offset:2048 sc1
    v_pk_mul_f32 v[224:225], v[192:193], v[38:39]
    v_pk_mul_f32 v[226:227], v[194:195], v[38:39]
    v_pk_mul_f32 v[228:229], v[196:197], v[38:39]
    v_pk_mul_f32 v[230:231], v[198:199], v[38:39]
    v_pk_mul_f32 v[232:233], v[200:201], v[38:39]
    v_pk_mul_f32 v[234:235], v[202:203], v[38:39]
    v_pk_mul_f32 v[236:237], v[204:205], v[38:39]
    v_pk_mul_f32 v[238:239], v[206:207], v[38:39]
    v_pk_fma_f32 v[144:145], v[144:145], v[36:37], v[224:225]
    v_pk_fma_f32 v[146:147], v[146:147], v[36:37], v[226:227]
    v_pk_fma_f32 v[148:149], v[148:149], v[36:37], v[228:229]
    v_pk_fma_f32 v[150:151], v[150:151], v[36:37], v[230:231]
    v_pk_fma_f32 v[152:153], v[152:153], v[36:37], v[232:233]
    v_pk_fma_f32 v[154:155], v[154:155], v[36:37], v[234:235]
    v_pk_fma_f32 v[156:157], v[156:157], v[36:37], v[236:237]
    v_pk_fma_f32 v[158:159], v[158:159], v[36:37], v[238:239]
    v_pk_mul_f32 v[224:225], v[144:145], v[144:145]
    v_pk_mul_f32 v[226:227], v[146:147], v[146:147]
    v_pk_mul_f32 v[228:229], v[148:149], v[148:149]
    v_pk_mul_f32 v[230:231], v[150:151], v[150:151]
    v_pk_fma_f32 v[224:225], v[224:225], v[62:63], v[60:61]
    v_pk_fma_f32 v[226:227], v[226:227], v[62:63], v[60:61]
    v_pk_fma_f32 v[228:229], v[228:229], v[62:63], v[60:61]
    v_pk_fma_f32 v[230:231], v[230:231], v[62:63], v[60:61]
    v_pk_mul_f32 v[224:225], v[224:225], v[144:145]
    v_pk_mul_f32 v[226:227], v[226:227], v[146:147]
    v_pk_mul_f32 v[228:229], v[228:229], v[148:149]
    v_pk_mul_f32 v[230:231], v[230:231], v[150:151]
    v_exp_f32 v224, v224
    v_exp_f32 v225, v225
    v_exp_f32 v226, v226
    v_exp_f32 v227, v227
    v_exp_f32 v228, v228
    v_exp_f32 v229, v229
    v_exp_f32 v230, v230
    v_exp_f32 v231, v231
    v_pk_mul_f32 v[144:145], v[144:145], v[152:153]
    v_pk_mul_f32 v[146:147], v[146:147], v[154:155]
    v_pk_mul_f32 v[148:149], v[148:149], v[156:157]
    v_pk_mul_f32 v[150:151], v[150:151], v[158:159]
    v_pk_add_f32 v[224:225], v[224:225], v[58:59]
    v_pk_add_f32 v[226:227], v[226:227], v[58:59]
    v_pk_add_f32 v[228:229], v[228:229], v[58:59]
    v_pk_add_f32 v[230:231], v[230:231], v[58:59]
    v_rcp_f32 v224, v224
    v_rcp_f32 v225, v225
    v_rcp_f32 v226, v226
    v_rcp_f32 v227, v227
    v_rcp_f32 v228, v228
    v_rcp_f32 v229, v229
    v_rcp_f32 v230, v230
    v_rcp_f32 v231, v231
    s_nop 0
    v_pk_mul_f32 v[144:145], v[144:145], v[224:225]
    v_pk_mul_f32 v[146:147], v[146:147], v[226:227]
    v_pk_mul_f32 v[148:149], v[148:149], v[228:229]
    v_pk_mul_f32 v[150:151], v[150:151], v[230:231]
    v_cvt_pk_bf16_f32 v48, v144, v145
    v_cvt_pk_bf16_f32 v49, v146, v147
    v_cvt_pk_bf16_f32 v50, v148, v149
    v_cvt_pk_bf16_f32 v51, v150, v151
    buffer_store_dwordx4 v[48:51], v57, s[76:79], 0 offen offset:2048 sc1
L_k3_glu_kernel_fin_3:
L_k3_glu_kernel_end_1:
    s_endpgm
.globl k4_down_kernel
.p2align 8
.type k4_down_kernel,@function
k4_down_kernel:
    s_cmp_ge_u32 s2, 256
    s_cbranch_scc1 L_k4_down_kernel_end_1
    s_load_dwordx2 s[4:5], s[0:1], 48
    s_load_dwordx2 s[6:7], s[0:1], 72
    s_load_dwordx2 s[60:61], s[0:1], 56
    s_and_b32 s20, s2, 7
    s_lshr_b32 s21, s2, 3
    s_and_b32 s22, s20, 1
    s_lshl_b32 s22, s22, 2
    s_and_b32 s23, s21, 3
    s_add_u32 s22, s22, s23
    s_lshr_b32 s23, s20, 1
    s_lshl_b32 s23, s23, 3
    s_lshr_b32 s24, s21, 2
    s_add_u32 s23, s23, s24
    s_lshl_b32 s24, s23, 6
    v_lshrrev_b32 v1, 6, v0
    v_and_b32 v2, 63, v0
    s_nop 0
    v_readfirstlane_b32 s25, v1
    s_lshr_b32 s26, s25, 1
    s_and_b32 s28, s25, 1
    s_lshr_b32 s27, s26, 1
    v_lshlrev_b32 v9, 4, v2
    s_lshl_b32 s30, s23, 1
    s_lshr_b32 s31, s25, 2
    s_add_u32 s30, s30, s31
    s_mul_i32 s30, s30, 224
    s_and_b32 s31, s25, 3
    s_add_u32 s30, s30, s31
    s_lshl_b32 s30, s30, 10
    v_add_u32 v10, s30, v9
    s_lshl_b32 s40, s25, 10
    s_lshl_b32 s30, s25, 3
    s_add_u32 s30, s30, 0
    v_bfe_u32 v6, v2, 2, 2
    v_add_u32 v6, s30, v6
    v_lshlrev_b32 v6, 11, v6
    v_lshrrev_b32 v7, 4, v2
    v_lshl_add_u32 v6, v7, 6, v6
    v_and_b32 v7, 3, v2
    v_lshl_add_u32 v6, v7, 4, v6
    s_lshl_b32 s31, s22, 8
    v_add_u32 v12, s31, v6
    s_lshl_b32 s42, s25, 11
    s_add_u32 s42, s42, 8192
    s_lshl_b32 s30, s25, 3
    s_add_u32 s30, s30, 4
    v_bfe_u32 v6, v2, 2, 2
    v_add_u32 v6, s30, v6
    v_lshlrev_b32 v6, 11, v6
    v_lshrrev_b32 v7, 4, v2
    v_lshl_add_u32 v6, v7, 6, v6
    v_and_b32 v7, 3, v2
    v_lshl_add_u32 v6, v7, 4, v6
    s_lshl_b32 s31, s22, 8
    v_add_u32 v13, s31, v6
    s_lshl_b32 s43, s25, 11
    s_add_u32 s43, s43, 9216
    s_mov_b32 s50, 0
    s_mov_b32 s51, 0
    s_waitcnt lgkmcnt(0)
    s_add_u32 s8, s6, 0x1800000
    s_addc_u32 s9, s7, 0
    s_and_b32 s9, s9, 0xffff
    s_mov_b32 s10, 0xe00000
    s_mov_b32 s11, 0x00020000
    s_mov_b32 s12, s4
    s_and_b32 s13, s5, 0xffff
    s_mov_b32 s14, 0x700000
    s_mov_b32 s15, 0x00020000
    s_mov_b32 s52, 0
    s_mov_b32 s53, 0
    s_add_u32 m0, s52, s40
    s_nop 0
    buffer_load_dwordx4 v10, s[8:11], s50 offen lds
    s_add_u32 m0, s52, s42
    s_nop 0
    buffer_load_dwordx4 v12, s[12:15], s51 offen lds
    s_add_u32 m0, s52, s43
    s_nop 0
    buffer_load_dwordx4 v13, s[12:15], s51 offen lds
    s_add_u32 s50, s50, 0x1000
    s_add_u32 s51, s51, 0x20000
    s_add_u32 s52, s52, 24576
    s_cmp_ge_u32 s52, 147456
    s_cselect_b32 s52, 0, s52
    s_add_u32 m0, s52, s40
    s_nop 0
    buffer_load_dwordx4 v10, s[8:11], s50 offen lds
    s_add_u32 m0, s52, s42
    s_nop 0
    buffer_load_dwordx4 v12, s[12:15], s51 offen lds
    s_add_u32 m0, s52, s43
    s_nop 0
    buffer_load_dwordx4 v13, s[12:15], s51 offen lds
    s_add_u32 s50, s50, 0x1000
    s_add_u32 s51, s51, 0x20000
    s_add_u32 s52, s52, 24576
    s_cmp_ge_u32 s52, 147456
    s_cselect_b32 s52, 0, s52
    s_add_u32 m0, s52, s40
    s_nop 0
    buffer_load_dwordx4 v10, s[8:11], s50 offen lds
    s_add_u32 m0, s52, s42
    s_nop 0
    buffer_load_dwordx4 v12, s[12:15], s51 offen lds
    s_add_u32 m0, s52, s43
    s_nop 0
    buffer_load_dwordx4 v13, s[12:15], s51 offen lds
    s_add_u32 s50, s50, 0x1000
    s_add_u32 s51, s51, 0x20000
    s_add_u32 s52, s52, 24576
    s_cmp_ge_u32 s52, 147456
    s_cselect_b32 s52, 0, s52
    s_add_u32 m0, s52, s40
    s_nop 0
    buffer_load_dwordx4 v10, s[8:11], s50 offen lds
    s_add_u32 m0, s52, s42
    s_nop 0
    buffer_load_dwordx4 v12, s[12:15], s51 offen lds
    s_add_u32 m0, s52, s43
    s_nop 0
    buffer_load_dwordx4 v13, s[12:15], s51 offen lds
    s_add_u32 s50, s50, 0x1000
    s_add_u32 s51, s51, 0x20000
    s_add_u32 s52, s52, 24576
    s_cmp_ge_u32 s52, 147456
    s_cselect_b32 s52, 0, s52
    s_add_u32 m0, s52, s40
    s_nop 0
    buffer_load_dwordx4 v10, s[8:11], s50 offen lds
    s_add_u32 m0, s52, s42
    s_nop 0
    buffer_load_dwordx4 v12, s[12:15], s51 offen lds
    s_add_u32 m0, s52, s43
    s_nop 0
    buffer_load_dwordx4 v13, s[12:15], s51 offen lds
    s_add_u32 s50, s50, 0x1000
    s_add_u32 s51, s51, 0x20000
    s_add_u32 s52, s52, 24576
    s_cmp_ge_u32 s52, 147456
    s_cselect_b32 s52, 0, s52
    s_xor_b32 s30, s27, 0
    s_lshl_b32 s30, s30, 2
    s_add_u32 s30, s30, s26
    s_lshl_b32 s30, s30, 10
    v_add_u32 v16, s30, v9
    s_xor_b32 s30, s27, 1
    s_lshl_b32 s30, s30, 2
    s_add_u32 s30, s30, s26
    s_lshl_b32 s30, s30, 10
    v_add_u32 v17, s30, v9
    v_bfe_u32 v3, v2, 2, 2
    v_lshlrev_b32 v3, 6, v3
    v_bfe_u32 v4, v2, 4, 1
    v_lshl_add_u32 v3, v4, 5, v3
    v_and_b32 v4, 3, v2
    v_lshl_add_u32 v3, v4, 3, v3
    v_lshrrev_b32 v4, 5, v2
    v_mul_u32_u24 v4, 1024, v4
    v_add_u32 v3, v3, v4
    s_and_b32 s30, s26, 1
    s_xor_b32 s30, s30, 0
    s_lshl_b32 s31, s28, 1
    s_add_u32 s30, s30, s31
    s_lshl_b32 s30, s30, 8
    s_lshl_b32 s31, s26, 12
    s_add_u32 s30, s30, s31
    s_add_u32 s30, s30, 8192
    v_add_u32 v18, s30, v3
    s_and_b32 s30, s26, 1
    s_xor_b32 s30, s30, 1
    s_lshl_b32 s31, s28, 1
    s_add_u32 s30, s30, s31
    s_lshl_b32 s30, s30, 8
    s_lshl_b32 s31, s26, 12
    s_add_u32 s30, s30, s31
    s_add_u32 s30, s30, 8192
    v_add_u32 v19, s30, v3
    v_mov_b32 v64, 0
    v_mov_b32 v65, 0
    v_mov_b32 v66, 0
    v_mov_b32 v67, 0
    v_mov_b32 v68, 0
    v_mov_b32 v69, 0
    v_mov_b32 v70, 0
    v_mov_b32 v71, 0
    v_mov_b32 v72, 0
    v_mov_b32 v73, 0
    v_mov_b32 v74, 0
    v_mov_b32 v75, 0
    v_mov_b32 v76, 0
    v_mov_b32 v77, 0
    v_mov_b32 v78, 0
    v_mov_b32 v79, 0
    v_mov_b32 v80, 0
    v_mov_b32 v81, 0
    v_mov_b32 v82, 0
    v_mov_b32 v83, 0
    v_mov_b32 v84, 0
    v_mov_b32 v85, 0
    v_mov_b32 v86, 0
    v_mov_b32 v87, 0
    v_mov_b32 v88, 0
    v_mov_b32 v89, 0
    v_mov_b32 v90, 0
    v_mov_b32 v91, 0
    v_mov_b32 v92, 0
    v_mov_b32 v93, 0
    v_mov_b32 v94, 0
    v_mov_b32 v95, 0
    v_mov_b32 v96, 0
    v_mov_b32 v97, 0
    v_mov_b32 v98, 0
    v_mov_b32 v99, 0
    v_mov_b32 v100, 0
    v_mov_b32 v101, 0
    v_mov_b32 v102, 0
    v_mov_b32 v103, 0
    v_mov_b32 v104, 0
    v_mov_b32 v105, 0
    v_mov_b32 v106, 0
    v_mov_b32 v107, 0
    v_mov_b32 v108, 0
    v_mov_b32 v109, 0
    v_mov_b32 v110, 0
    v_mov_b32 v111, 0
    v_mov_b32 v112, 0
    v_mov_b32 v113, 0
    v_mov_b32 v114, 0
    v_mov_b32 v115, 0
    v_mov_b32 v116, 0
    v_mov_b32 v117, 0
    v_mov_b32 v118, 0
    v_mov_b32 v119, 0
    v_mov_b32 v120, 0
    v_mov_b32 v121, 0
    v_mov_b32 v122, 0
    v_mov_b32 v123, 0
    v_mov_b32 v124, 0
    v_mov_b32 v125, 0
    v_mov_b32 v126, 0
    v_mov_b32 v127, 0
    s_and_b32 s31, s26, 1
    s_lshl_b32 s32, s28, 1
    s_add_u32 s29, s31, s32
    s_lshl_b32 s32, s22, 2
    s_add_u32 s33, s29, s32
    s_lshl_b32 s30, s23, 1
    s_add_u32 s30, s30, s27
    s_lshl_b32 s30, s30, 6
    s_lshl_b32 s31, s33, 1
    s_add_u32 s30, s30, s31
    s_lshl_b32 s30, s30, 10
    v_add_u32 v7, s30, v9
    s_mov_b32 s16, s60
    s_and_b32 s17, s61, 0xffff
    s_mov_b32 s18, 0x400000
    s_mov_b32 s19, 0x00020000
    s_add_u32 s56, s6, 0x1400000
    s_addc_u32 s57, s7, 0
    s_and_b32 s57, s57, 0xffff
    s_mov_b32 s58, 0x400000
    s_mov_b32 s59, 0x00020000
    s_mov_b32 s97, -122880
    s_waitcnt vmcnt(12)
    s_barrier
    ds_read_b128 v[128:131], v16 offset:0
    ds_read_b64_tr_b16 v[136:137], v18 offset:0
    ds_read_b64_tr_b16 v[138:139], v18 offset:2048
    ds_read_b64_tr_b16 v[140:141], v19 offset:0
    ds_read_b64_tr_b16 v[142:143], v19 offset:2048
    ds_read_b128 v[132:135], v17 offset:0
    s_mov_b32 s54, 25
L_k4_down_kernel_loop_2:
    s_waitcnt vmcnt(9)
    s_barrier
    s_add_u32 s53, s53, 24576
    s_cmp_ge_u32 s53, 147456
    s_cselect_b32 s53, 0, s53
    s_cselect_b32 s96, s97, 24576
    v_add_u32 v16, s96, v16
    v_add_u32 v17, s96, v17
    v_add_u32 v18, s96, v18
    v_add_u32 v19, s96, v19
    s_waitcnt lgkmcnt(3)
    v_mfma_f32_32x32x16_bf16 v[64:79], v[136:139], v[128:131], v[64:79]
    ds_read_b128 v[144:147], v16 offset:0
    ds_read_b64_tr_b16 v[152:153], v18 offset:0
    s_add_u32 m0, s52, s40
    s_nop 0
    buffer_load_dwordx4 v10, s[8:11], s50 offen lds
    s_waitcnt lgkmcnt(3)
    v_mfma_f32_32x32x16_bf16 v[80:95], v[140:143], v[128:131], v[80:95]
    ds_read_b64_tr_b16 v[154:155], v18 offset:2048
    s_add_u32 m0, s52, s42
    s_nop 0
    buffer_load_dwordx4 v12, s[12:15], s51 offen lds
    s_waitcnt lgkmcnt(3)
    v_mfma_f32_32x32x16_bf16 v[96:111], v[136:139], v[132:135], v[96:111]
    ds_read_b64_tr_b16 v[156:157], v19 offset:0
    ds_read_b64_tr_b16 v[158:159], v19 offset:2048
    s_add_u32 m0, s52, s43
    s_nop 0
    buffer_load_dwordx4 v13, s[12:15], s51 offen lds
    s_add_u32 s50, s50, 0x1000
    s_add_u32 s51, s51, 0x20000
    s_add_u32 s52, s52, 24576
    s_cmp_ge_u32 s52, 147456
    s_cselect_b32 s52, 0, s52
    v_mfma_f32_32x32x16_bf16 v[112:127], v[140:143], v[132:135], v[112:127]
    ds_read_b128 v[148:151], v17 offset:0
    s_waitcnt vmcnt(9)
    s_barrier
    s_add_u32 s53, s53, 24576
    s_cmp_ge_u32 s53, 147456
    s_cselect_b32 s53, 0, s53
    s_cselect_b32 s96, s97, 24576
    v_add_u32 v16, s96, v16
    v_add_u32 v17, s96, v17
    v_add_u32 v18, s96, v18
    v_add_u32 v19, s96, v19
    s_waitcnt lgkmcnt(3)
    v_mfma_f32_32x32x16_bf16 v[64:79], v[152:155], v[144:147], v[64:79]
    ds_read_b128 v[128:131], v16 offset:0
    ds_read_b64_tr_b16 v[136:137], v18 offset:0
    s_add_u32 m0, s52, s40
    s_nop 0
    buffer_load_dwordx4 v10, s[8:11], s50 offen lds
    s_waitcnt lgkmcnt(3)
    v_mfma_f32_32x32x16_bf16 v[80:95], v[156:159], v[144:147], v[80:95]
    ds_read_b64_tr_b16 v[138:139], v18 offset:2048
    s_add_u32 m0, s52, s42
    s_nop 0
    buffer_load_dwordx4 v12, s[12:15], s51 offen lds
    s_waitcnt lgkmcnt(3)
    v_mfma_f32_32x32x16_bf16 v[96:111], v[152:155], v[148:151], v[96:111]
    ds_read_b64_tr_b16 v[140:141], v19 offset:0
    ds_read_b64_tr_b16 v[142:143], v19 offset:2048
    s_add_u32 m0, s52, s43
    s_nop 0
    buffer_load_dwordx4 v13, s[12:15], s51 offen lds
    s_add_u32 s50, s50, 0x1000
    s_add_u32 s51, s51, 0x20000
    s_add_u32 s52, s52, 24576
    s_cmp_ge_u32 s52, 147456
    s_cselect_b32 s52, 0, s52
    v_mfma_f32_32x32x16_bf16 v[112:127], v[156:159], v[148:151], v[112:127]
    ds_read_b128 v[132:135], v17 offset:0
    s_sub_u32 s54, s54, 1
    s_cmp_lg_u32 s54, 0
    s_cbranch_scc1 L_k4_down_kernel_loop_2
    s_waitcnt vmcnt(9)
    s_barrier
    s_add_u32 s53, s53, 24576
    s_cmp_ge_u32 s53, 147456
    s_cselect_b32 s53, 0, s53
    s_cselect_b32 s96, s97, 24576
    v_add_u32 v16, s96, v16
    v_add_u32 v17, s96, v17
    v_add_u32 v18, s96, v18
    v_add_u32 v19, s96, v19
    s_waitcnt lgkmcnt(3)
    v_mfma_f32_32x32x16_bf16 v[64:79], v[136:139], v[128:131], v[64:79]
    ds_read_b128 v[144:147], v16 offset:0
    ds_read_b64_tr_b16 v[152:153], v18 offset:0
    s_add_u32 m0, s52, s40
    s_nop 0
    buffer_load_dwordx4 v10, s[8:11], s50 offen lds
    s_waitcnt lgkmcnt(3)
    v_mfma_f32_32x32x16_bf16 v[80:95], v[140:143], v[128:131], v[80:95]
    ds_read_b64_tr_b16 v[154:155], v18 offset:2048
    s_add_u32 m0, s52, s42
    s_nop 0
    buffer_load_dwordx4 v12, s[12:15], s51 offen lds
    s_waitcnt lgkmcnt(3)
    v_mfma_f32_32x32x16_bf16 v[96:111], v[136:139], v[132:135], v[96:111]
    ds_read_b64_tr_b16 v[156:157], v19 offset:0
    ds_read_b64_tr_b16 v[158:159], v19 offset:2048
    s_add_u32 m0, s52, s43
    s_nop 0
    buffer_load_dwordx4 v13, s[12:15], s51 offen lds
    s_add_u32 s50, s50, 0x1000
    s_add_u32 s51, s51, 0x20000
    s_add_u32 s52, s52, 24576
    s_cmp_ge_u32 s52, 147456
    s_cselect_b32 s52, 0, s52
    v_mfma_f32_32x32x16_bf16 v[112:127], v[140:143], v[132:135], v[112:127]
    ds_read_b128 v[148:151], v17 offset:0
    s_waitcnt vmcnt(9)
    s_barrier
    s_add_u32 s53, s53, 24576
    s_cmp_ge_u32 s53, 147456
    s_cselect_b32 s53, 0, s53
    s_cselect_b32 s96, s97, 24576
    v_add_u32 v16, s96, v16
    v_add_u32 v17, s96, v17
    v_add_u32 v18, s96, v18
    v_add_u32 v19, s96, v19
    s_waitcnt lgkmcnt(3)
    v_mfma_f32_32x32x16_bf16 v[64:79], v[152:155], v[144:147], v[64:79]
    ds_read_b128 v[128:131], v16 offset:0
    ds_read_b64_tr_b16 v[136:137], v18 offset:0
    s_waitcnt lgkmcnt(3)
    v_mfma_f32_32x32x16_bf16 v[80:95], v[156:159], v[144:147], v[80:95]
    ds_read_b64_tr_b16 v[138:139], v18 offset:2048
    s_waitcnt lgkmcnt(3)
    v_mfma_f32_32x32x16_bf16 v[96:111], v[152:155], v[148:151], v[96:111]
    ds_read_b64_tr_b16 v[140:141], v19 offset:0
    ds_read_b64_tr_b16 v[142:143], v19 offset:2048
    v_mfma_f32_32x32x16_bf16 v[112:127], v[156:159], v[148:151], v[112:127]
    ds_read_b128 v[132:135], v17 offset:0
    buffer_load_dwordx4 v[32:35], v7, s[56:59], 0 offen offset:0
    buffer_load_dwordx4 v[36:39], v7, s[56:59], 0 offen offset:1024
    s_waitcnt vmcnt(8)
    s_barrier
    s_add_u32 s53, s53, 24576
    s_cmp_ge_u32 s53, 147456
    s_cselect_b32 s53, 0, s53
    s_cselect_b32 s96, s97, 24576
    v_add_u32 v16, s96, v16
    v_add_u32 v17, s96, v17
    v_add_u32 v18, s96, v18
    v_add_u32 v19, s96, v19
    s_waitcnt lgkmcnt(3)
    v_mfma_f32_32x32x16_bf16 v[64:79], v[136:139], v[128:131], v[64:79]
    ds_read_b128 v[144:147], v16 offset:0
    ds_read_b64_tr_b16 v[152:153], v18 offset:0
    s_waitcnt lgkmcnt(3)
    v_mfma_f32_32x32x16_bf16 v[80:95], v[140:143], v[128:131], v[80:95]
    ds_read_b64_tr_b16 v[154:155], v18 offset:2048
    s_waitcnt lgkmcnt(3)
    v_mfma_f32_32x32x16_bf16 v[96:111], v[136:139], v[132:135], v[96:111]
    ds_read_b64_tr_b16 v[156:157], v19 offset:0
    ds_read_b64_tr_b16 v[158:159], v19 offset:2048
    v_mfma_f32_32x32x16_bf16 v[112:127], v[140:143], v[132:135], v[112:127]
    ds_read_b128 v[148:151], v17 offset:0
    s_waitcnt vmcnt(5)
    s_barrier
    s_add_u32 s53, s53, 24576
    s_cmp_ge_u32 s53, 147456
    s_cselect_b32 s53, 0, s53
    s_cselect_b32 s96, s97, 24576
    v_add_u32 v16, s96, v16
    v_add_u32 v17, s96, v17
    v_add_u32 v18, s96, v18
    v_add_u32 v19, s96, v19
    s_waitcnt lgkmcnt(3)
    v_mfma_f32_32x32x16_bf16 v[64:79], v[152:155], v[144:147], v[64:79]
    ds_read_b128 v[128:131], v16 offset:0
    ds_read_b64_tr_b16 v[136:137], v18 offset:0
    s_waitcnt lgkmcnt(3)
    v_mfma_f32_32x32x16_bf16 v[80:95], v[156:159], v[144:147], v[80:95]
    ds_read_b64_tr_b16 v[138:139], v18 offset:2048
    s_waitcnt lgkmcnt(3)
    v_mfma_f32_32x32x16_bf16 v[96:111], v[152:155], v[148:151], v[96:111]
    ds_read_b64_tr_b16 v[140:141], v19 offset:0
    ds_read_b64_tr_b16 v[142:143], v19 offset:2048
    v_mfma_f32_32x32x16_bf16 v[112:127], v[156:159], v[148:151], v[112:127]
    ds_read_b128 v[132:135], v17 offset:0
    s_waitcnt vmcnt(2)
    s_barrier
    s_add_u32 s53, s53, 24576
    s_cmp_ge_u32 s53, 147456
    s_cselect_b32 s53, 0, s53
    s_cselect_b32 s96, s97, 24576
    v_add_u32 v16, s96, v16
    v_add_u32 v17, s96, v17
    v_add_u32 v18, s96, v18
    v_add_u32 v19, s96, v19
    s_waitcnt lgkmcnt(3)
    v_mfma_f32_32x32x16_bf16 v[64:79], v[136:139], v[128:131], v[64:79]
    ds_read_b128 v[144:147], v16 offset:0
    ds_read_b64_tr_b16 v[152:153], v18 offset:0
    s_waitcnt lgkmcnt(3)
    v_mfma_f32_32x32x16_bf16 v[80:95], v[140:143], v[128:131], v[80:95]
    ds_read_b64_tr_b16 v[154:155], v18 offset:2048
    s_waitcnt lgkmcnt(3)
    v_mfma_f32_32x32x16_bf16 v[96:111], v[136:139], v[132:135], v[96:111]
    ds_read_b64_tr_b16 v[156:157], v19 offset:0
    ds_read_b64_tr_b16 v[158:159], v19 offset:2048
    v_mfma_f32_32x32x16_bf16 v[112:127], v[140:143], v[132:135], v[112:127]
    ds_read_b128 v[148:151], v17 offset:0
    s_waitcnt vmcnt(2)
    s_barrier
    s_waitcnt lgkmcnt(3)
    v_mfma_f32_32x32x16_bf16 v[64:79], v[152:155], v[144:147], v[64:79]
    s_waitcnt lgkmcnt(1)
    v_mfma_f32_32x32x16_bf16 v[80:95], v[156:159], v[144:147], v[80:95]
    s_waitcnt lgkmcnt(0)
    v_mfma_f32_32x32x16_bf16 v[96:111], v[152:155], v[148:151], v[96:111]
    v_mfma_f32_32x32x16_bf16 v[112:127], v[156:159], v[148:151], v[112:127]
    s_xor_b32 s30, s26, 1
    s_lshl_b32 s34, s28, 2
    s_add_u32 s30, s30, s34
    s_mul_i32 s30, s30, 3
    s_add_u32 s30, s30, 0
    s_lshl_b32 s30, s30, 12
    v_add_u32 v21, s30, v9
    s_xor_b32 s30, s26, 2
    s_lshl_b32 s34, s28, 2
    s_add_u32 s30, s30, s34
    s_mul_i32 s30, s30, 3
    s_add_u32 s30, s30, 1
    s_lshl_b32 s30, s30, 12
    v_add_u32 v22, s30, v9
    s_xor_b32 s30, s26, 3
    s_lshl_b32 s34, s28, 2
    s_add_u32 s30, s30, s34
    s_mul_i32 s30, s30, 3
    s_add_u32 s30, s30, 2
    s_lshl_b32 s30, s30, 12
    v_add_u32 v23, s30, v9
    s_lshl_b32 s34, s28, 2
    s_add_u32 s30, s26, s34
    s_mul_i32 s30, s30, 12288
    v_add_u32 v20, s30, v9
    v_mov_b32 v60, 0xffff0000
    s_nop 4
    s_barrier
    ds_write_b128 v21, v[80:83] offset:0
    ds_write_b128 v21, v[84:87] offset:1024
    ds_write_b128 v21, v[88:91] offset:2048
    ds_write_b128 v21, v[92:95] offset:3072
    ds_write_b128 v22, v[96:99] offset:0
    ds_write_b128 v22, v[100:103] offset:1024
    ds_write_b128 v22, v[104:107] offset:2048
    ds_write_b128 v22, v[108:111] offset:3072
    ds_write_b128 v23, v[112:115] offset:0
    ds_write_b128 v23, v[116:119] offset:1024
    ds_write_b128 v23, v[120:123] offset:2048
    ds_write_b128 v23, v[124:127] offset:3072
    s_waitcnt lgkmcnt(0)
    s_barrier
    ds_read_b128 v[80:83], v20 offset:0
    ds_read_b128 v[84:87], v20 offset:1024
    ds_read_b128 v[88:91], v20 offset:2048
    ds_read_b128 v[92:95], v20 offset:3072
    ds_read_b128 v[96:99], v20 offset:4096
    ds_read_b128 v[100:103], v20 offset:5120
    ds_read_b128 v[104:107], v20 offset:6144
    ds_read_b128 v[108:111], v20 offset:7168
    ds_read_b128 v[112:115], v20 offset:8192
    ds_read_b128 v[116:119], v20 offset:9216
    ds_read_b128 v[120:123], v20 offset:10240
    ds_read_b128 v[124:127], v20 offset:11264
    s_waitcnt lgkmcnt(8)
    v_pk_add_f32 v[64:65], v[64:65], v[80:81]
    v_pk_add_f32 v[66:67], v[66:67], v[82:83]
    v_pk_add_f32 v[68:69], v[68:69], v[84:85]
    v_pk_add_f32 v[70:71], v[70:71], v[86:87]
    v_pk_add_f32 v[72:73], v[72:73], v[88:89]
    v_pk_add_f32 v[74:75], v[74:75], v[90:91]
    v_pk_add_f32 v[76:77], v[76:77], v[92:93]
    v_pk_add_f32 v[78:79], v[78:79], v[94:95]
    s_waitcnt lgkmcnt(0)
    v_pk_add_f32 v[96:97], v[96:97], v[112:113]
    v_pk_add_f32 v[98:99], v[98:99], v[114:115]
    v_pk_add_f32 v[100:101], v[100:101], v[116:117]
    v_pk_add_f32 v[102:103], v[102:103], v[118:119]
    v_pk_add_f32 v[104:105], v[104:105], v[120:121]
    v_pk_add_f32 v[106:107], v[106:107], v[122:123]
    v_pk_add_f32 v[108:109], v[108:109], v[124:125]
    v_pk_add_f32 v[110:111], v[110:111], v[126:127]
    v_pk_add_f32 v[64:65], v[64:65], v[96:97]
    v_pk_add_f32 v[66:67], v[66:67], v[98:99]
    v_pk_add_f32 v[68:69], v[68:69], v[100:101]
    v_pk_add_f32 v[70:71], v[70:71], v[102:103]
    v_pk_add_f32 v[72:73], v[72:73], v[104:105]
    v_pk_add_f32 v[74:75], v[74:75], v[106:107]
    v_pk_add_f32 v[76:77], v[76:77], v[108:109]
    v_pk_add_f32 v[78:79], v[78:79], v[110:111]
    s_waitcnt vmcnt(0)
    v_cvt_pk_bf16_f32 v40, v64, v65
    v_cvt_pk_bf16_f32 v41, v66, v67
    v_cvt_pk_bf16_f32 v42, v68, v69
    v_cvt_pk_bf16_f32 v43, v70, v71
    v_cvt_pk_bf16_f32 v44, v72, v73
    v_cvt_pk_bf16_f32 v45, v74, v75
    v_cvt_pk_bf16_f32 v46, v76, v77
    v_cvt_pk_bf16_f32 v47, v78, v79
    v_lshlrev_b32 v80, 16, v40
    v_and_b32 v81, v60, v40
    v_lshlrev_b32 v96, 16, v32
    v_and_b32 v97, v60, v32
    v_lshlrev_b32 v82, 16, v41
    v_and_b32 v83, v60, v41
    v_lshlrev_b32 v98, 16, v33
    v_and_b32 v99, v60, v33
    v_lshlrev_b32 v84, 16, v42
    v_and_b32 v85, v60, v42
    v_lshlrev_b32 v100, 16, v34
    v_and_b32 v101, v60, v34
    v_lshlrev_b32 v86, 16, v43
    v_and_b32 v87, v60, v43
    v_lshlrev_b32 v102, 16, v35
    v_and_b32 v103, v60, v35
    v_lshlrev_b32 v88, 16, v44
    v_and_b32 v89, v60, v44
    v_lshlrev_b32 v104, 16, v36
    v_and_b32 v105, v60, v36
    v_lshlrev_b32 v90, 16, v45
    v_and_b32 v91, v60, v45
    v_lshlrev_b32 v106, 16, v37
    v_and_b32 v107, v60, v37
    v_lshlrev_b32 v92, 16, v46
    v_and_b32 v93, v60, v46
    v_lshlrev_b32 v108, 16, v38
    v_and_b32 v109, v60, v38
    v_lshlrev_b32 v94, 16, v47
    v_and_b32 v95, v60, v47
    v_lshlrev_b32 v110, 16, v39
    v_and_b32 v111, v60, v39
    v_pk_add_f32 v[80:81], v[80:81], v[96:97]
    v_pk_add_f32 v[82:83], v[82:83], v[98:99]
    v_pk_add_f32 v[84:85], v[84:85], v[100:101]
    v_pk_add_f32 v[86:87], v[86:87], v[102:103]
    v_pk_add_f32 v[88:89], v[88:89], v[104:105]
    v_pk_add_f32 v[90:91], v[90:91], v[106:107]
    v_pk_add_f32 v[92:93], v[92:93], v[108:109]
    v_pk_add_f32 v[94:95], v[94:95], v[110:111]
    v_cvt_pk_bf16_f32 v48, v80, v81
    v_cvt_pk_bf16_f32 v49, v82, v83
    v_cvt_pk_bf16_f32 v50, v84, v85
    v_cvt_pk_bf16_f32 v51, v86, v87
    v_cvt_pk_bf16_f32 v52, v88, v89
    v_cvt_pk_bf16_f32 v53, v90, v91
    v_cvt_pk_bf16_f32 v54, v92, v93
    v_cvt_pk_bf16_f32 v55, v94, v95
    s_lshl_b32 s30, s27, 5
    v_and_b32 v3, 31, v2
    v_add_u32 v3, s30, v3
    v_mul_u32_u24 v3, 272, v3
    v_lshrrev_b32 v5, 5, v2
    v_lshl_add_u32 v3, v5, 3, v3
    s_lshl_b32 s30, s29, 6
    s_add_u32 s30, s30, 98304
    v_add_u32 v3, s30, v3
    ds_write_b64 v3, v[48:49] offset:0
    ds_write_b64 v3, v[50:51] offset:16
    ds_write_b64 v3, v[52:53] offset:32
    ds_write_b64 v3, v[54:55] offset:48
    v_lshrrev_b32 v4, 4, v2
    s_lshl_b32 s30, s25, 3
    v_add_u32 v4, s30, v4
    v_and_b32 v5, 15, v2
    v_mul_u32_u24 v6, 272, v4
    v_lshl_add_u32 v6, v5, 4, v6
    v_add_u32 v6, 98304, v6
    v_add_u32 v4, s24, v4
    v_lshlrev_b32 v4, 11, v4
    v_lshl_add_u32 v4, v5, 4, v4
    s_lshl_b32 s30, s22, 8
    v_add_u32 v4, s30, v4
    v_add_u32 v5, 8192, v4
    s_waitcnt lgkmcnt(0)
    s_barrier
    ds_read_b128 v[32:35], v6
    ds_read_b128 v[36:39], v6 offset:1088
    s_waitcnt lgkmcnt(1)
    buffer_store_dwordx4 v[32:35], v4, s[16:19], 0 offen sc1
    s_waitcnt lgkmcnt(0)
    buffer_store_dwordx4 v[36:39], v5, s[16:19], 0 offen sc1
L_k4_down_kernel_end_1:
    s_endpgm
.section .rodata,"a"
.p2align 6
.amdhsa_kernel k0_ln_kernel
  .amdhsa_next_free_vgpr 80
  .amdhsa_next_free_sgpr 102
  .amdhsa_accum_offset 80
  .amdhsa_group_segment_fixed_size 0
  .amdhsa_kernarg_size 80
  .amdhsa_user_sgpr_count 2
  .amdhsa_user_sgpr_kernarg_segment_ptr 1
  .amdhsa_system_sgpr_workgroup_id_x 1
.end_amdhsa_kernel
.p2align 6
.amdhsa_kernel k1_qkv_kernel
  .amdhsa_next_free_vgpr 168
  .amdhsa_next_free_sgpr 102
  .amdhsa_accum_offset 168
  .amdhsa_group_segment_fixed_size 0
  .amdhsa_kernarg_size 80
  .amdhsa_user_sgpr_count 2
  .amdhsa_user_sgpr_kernarg_segment_ptr 1
  .amdhsa_system_sgpr_workgroup_id_x 1
.end_amdhsa_kernel
.p2align 6
.amdhsa_kernel k15_o_kernel
  .amdhsa_next_free_vgpr 176
  .amdhsa_next_free_sgpr 102
  .amdhsa_accum_offset 176
  .amdhsa_group_segment_fixed_size 0
  .amdhsa_kernarg_size 80
  .amdhsa_user_sgpr_count 2
  .amdhsa_user_sgpr_kernarg_segment_ptr 1
  .amdhsa_system_sgpr_workgroup_id_x 1
.end_amdhsa_kernel
.p2align 6
.amdhsa_kernel k2_wo_kernel
  .amdhsa_next_free_vgpr 160
  .amdhsa_next_free_sgpr 102
  .amdhsa_accum_offset 160
  .amdhsa_group_segment_fixed_size 0
  .amdhsa_kernarg_size 80
  .amdhsa_user_sgpr_count 2
  .amdhsa_user_sgpr_kernarg_segment_ptr 1
  .amdhsa_system_sgpr_workgroup_id_x 1
.end_amdhsa_kernel
.p2align 6
.amdhsa_kernel k3_glu_kernel
  .amdhsa_next_free_vgpr 240
  .amdhsa_next_free_sgpr 102
  .amdhsa_accum_offset 240
  .amdhsa_group_segment_fixed_size 0
  .amdhsa_kernarg_size 80
  .amdhsa_user_sgpr_count 2
  .amdhsa_user_sgpr_kernarg_segment_ptr 1
  .amdhsa_system_sgpr_workgroup_id_x 1
.end_amdhsa_kernel
.p2align 6
.amdhsa_kernel k4_down_kernel
  .amdhsa_next_free_vgpr 160
  .amdhsa_next_free_sgpr 102
  .amdhsa_accum_offset 160
  .amdhsa_group_segment_fixed_size 0
  .amdhsa_kernarg_size 80
  .amdhsa_user_sgpr_count 2
  .amdhsa_user_sgpr_kernarg_segment_ptr 1
  .amdhsa_system_sgpr_workgroup_id_x 1
.end_amdhsa_kernel
```
